```python
import torch

def _softmax(x, axis=-1):
    return torch.softmax(x, dim=axis)
def _gelu(x):
    return torch.nn.functional.gelu(x, approximate="tanh")
def _silu(x):
    return torch.nn.functional.silu(x)
def _sigmoid(x):
    return torch.sigmoid(x)
def _layernorm(x, axis=-1, eps=1e-5):
    m = x.mean(dim=axis, keepdim=True)
    v = x.var(dim=axis, keepdim=True, unbiased=False)
    return (x - m) / torch.sqrt(v + eps)
def _scatter_add(tgt, idx, src, axis=0):
    return tgt.clone().index_add_(axis, idx, src)
def _segment_sum(src, seg, n):
    out = torch.zeros((n,) + src.shape[1:], dtype=src.dtype)
    return out.index_add_(0, seg, src)
def _pad(x, pw):
    flat = tuple(v for pair in reversed(pw) for v in pair)
    return torch.nn.functional.pad(x, flat)

kernel_name = 'standalone__instancenorm__prompt'

def setup_inputs():

    _w = (lambda a: (lambda t: t.to(torch.bfloat16) if t.is_floating_point() else t)(torch.as_tensor(a)))
    B, C, H, W = 2, 640, 2048, 32
    return {
        "x": _w(abs((lambda *s: torch.randn(*s, dtype=torch.bfloat16) * 0.05)(B, C, H, W))),
        "g": _w((lambda *s: torch.randn(*s, dtype=torch.bfloat16) * 0.05)(C) + 1.0),
        "b": _w((lambda *s: torch.randn(*s, dtype=torch.bfloat16) * 0.4)(C)),
    }

def reference(x, g, b):
    mu = x.mean(axis=(-2, -1), keepdims=True)
    var = ((x - mu) ** 2).mean(axis=(-2, -1), keepdims=True)
    xhat = (x - mu) / torch.sqrt(var + 1e-5)
    return xhat * g.reshape(1, -1, 1, 1) + b.reshape(1, -1, 1, 1)
```

```asm
; @launch grid=(256,1,1) block=(1024,1,1) lds=1536
.amdgcn_target "amdgcn-amd-amdhsa--gfx950"
.text
.globl standalone__instancenorm__prompt_kernel
.p2align 8
.type standalone__instancenorm__prompt_kernel,@function
standalone__instancenorm__prompt_kernel:
    s_cmp_ge_u32 s2, 256
    s_cbranch_scc1 L_end
    s_load_dwordx4 s[4:7], s[0:1], 0
    s_load_dwordx4 s[8:11], s[0:1], 16
    s_load_dwordx2 s[12:13], s[0:1], 32
    v_lshrrev_b32 v2, 6, v0
    v_and_b32 v3, 63, v0
    v_mul_u32_u24 v1, 8192, v2
    v_lshl_add_u32 v1, v3, 4, v1
    v_readfirstlane_b32 s62, v2
    v_lshlrev_b32 v2, 2, v2
    v_mov_b32 v3, 0
    v_mov_b32 v4, 0x3f803f80
    s_mov_b32 s27, 0xffff0000
    s_mov_b32 s28, 0
    s_mov_b32 s29, 0x80000000
    s_mov_b32 s66, 0x00003f80
    s_mov_b32 s67, 0x3f800000
    s_mov_b32 s63, 0xffff
    s_mov_b32 s14, s2
    s_lshl_b32 s32, s14, 17
    s_add_u32 s33, s32, 4096
    s_sub_u32 s15, s14, 640
    s_cmp_ge_u32 s14, 640
    s_cselect_b32 s56, s15, s14
    s_add_u32 s14, s14, 256
    s_lshl_b32 s34, s14, 17
    s_add_u32 s35, s34, 4096
    s_sub_u32 s15, s14, 640
    s_cmp_ge_u32 s14, 640
    s_cselect_b32 s57, s15, s14
    s_add_u32 s14, s14, 256
    s_lshl_b32 s36, s14, 17
    s_add_u32 s37, s36, 4096
    s_sub_u32 s15, s14, 640
    s_cmp_ge_u32 s14, 640
    s_cselect_b32 s58, s15, s14
    s_add_u32 s14, s14, 256
    s_lshl_b32 s38, s14, 17
    s_add_u32 s39, s38, 4096
    s_sub_u32 s15, s14, 640
    s_cmp_ge_u32 s14, 640
    s_cselect_b32 s59, s15, s14
    s_waitcnt lgkmcnt(0)
    s_mov_b32 s16, s4
    s_and_b32 s17, s5, 0xffff
    s_mov_b32 s18, 167772160
    s_mov_b32 s19, 0x00020000
    s_mov_b32 s20, s10
    s_and_b32 s21, s11, 0xffff
    s_mov_b32 s22, 167772160
    s_mov_b32 s23, 0x00020000
    s_mov_b32 s92, s4
    s_and_b32 s93, s5, 0xffff
    s_mov_b32 s94, 0
    s_mov_b32 s95, 0x00020000
    buffer_load_dwordx4 v[32:35], v1, s[16:19], s32 offen offset:0 nt
    buffer_load_dwordx4 v[36:39], v1, s[16:19], s32 offen offset:1024 nt
    buffer_load_dwordx4 v[40:43], v1, s[16:19], s32 offen offset:2048 nt
    buffer_load_dwordx4 v[44:47], v1, s[16:19], s32 offen offset:3072 nt
    buffer_load_dwordx4 v[48:51], v1, s[16:19], s33 offen offset:0 nt
    buffer_load_dwordx4 v[52:55], v1, s[16:19], s33 offen offset:1024 nt
    buffer_load_dwordx4 v[56:59], v1, s[16:19], s33 offen offset:2048 nt
    buffer_load_dwordx4 v[60:63], v1, s[16:19], s33 offen offset:3072 nt
    s_lshl_b32 s15, s56, 1
    s_and_b32 s15, s15, 0xfffffffc
    s_load_dword s44, s[6:7], s15
    s_load_dword s50, s[8:9], s15
    s_lshl_b32 s15, s57, 1
    s_and_b32 s15, s15, 0xfffffffc
    s_load_dword s45, s[6:7], s15
    s_load_dword s51, s[8:9], s15
    s_lshl_b32 s15, s58, 1
    s_and_b32 s15, s15, 0xfffffffc
    s_load_dword s46, s[6:7], s15
    s_load_dword s52, s[8:9], s15
    s_lshl_b32 s15, s59, 1
    s_and_b32 s15, s15, 0xfffffffc
    s_load_dword s47, s[6:7], s15
    s_load_dword s53, s[8:9], s15
    s_barrier
    buffer_load_dwordx4 v[64:67], v1, s[16:19], s34 offen offset:0 nt
    buffer_load_dwordx4 v[68:71], v1, s[16:19], s34 offen offset:1024 nt
    buffer_load_dwordx4 v[72:75], v1, s[16:19], s34 offen offset:2048 nt
    buffer_load_dwordx4 v[76:79], v1, s[16:19], s34 offen offset:3072 nt
    buffer_load_dwordx4 v[80:83], v1, s[16:19], s35 offen offset:0 nt
    buffer_load_dwordx4 v[84:87], v1, s[16:19], s35 offen offset:1024 nt
    buffer_load_dwordx4 v[88:91], v1, s[16:19], s35 offen offset:2048 nt
    buffer_load_dwordx4 v[92:95], v1, s[16:19], s35 offen offset:3072 nt
    v_mov_b32 v6, 0
    v_mov_b32 v7, 0
    v_mov_b32 v8, 0
    v_mov_b32 v9, 0
    s_waitcnt vmcnt(15)
    v_dot2c_f32_bf16 v6, v32, v4
    v_dot2c_f32_bf16 v7, v33, v4
    v_dot2c_f32_bf16 v8, v34, v4
    v_dot2c_f32_bf16 v9, v35, v4
    s_waitcnt vmcnt(14)
    v_dot2c_f32_bf16 v6, v36, v4
    v_dot2c_f32_bf16 v7, v37, v4
    v_dot2c_f32_bf16 v8, v38, v4
    v_dot2c_f32_bf16 v9, v39, v4
    s_waitcnt vmcnt(13)
    v_dot2c_f32_bf16 v6, v40, v4
    v_dot2c_f32_bf16 v7, v41, v4
    v_dot2c_f32_bf16 v8, v42, v4
    v_dot2c_f32_bf16 v9, v43, v4
    s_waitcnt vmcnt(12)
    v_dot2c_f32_bf16 v6, v44, v4
    v_dot2c_f32_bf16 v7, v45, v4
    v_dot2c_f32_bf16 v8, v46, v4
    v_dot2c_f32_bf16 v9, v47, v4
    s_waitcnt vmcnt(11)
    v_dot2c_f32_bf16 v6, v48, v4
    v_dot2c_f32_bf16 v7, v49, v4
    v_dot2c_f32_bf16 v8, v50, v4
    v_dot2c_f32_bf16 v9, v51, v4
    s_waitcnt vmcnt(10)
    v_dot2c_f32_bf16 v6, v52, v4
    v_dot2c_f32_bf16 v7, v53, v4
    v_dot2c_f32_bf16 v8, v54, v4
    v_dot2c_f32_bf16 v9, v55, v4
    s_waitcnt vmcnt(9)
    v_dot2c_f32_bf16 v6, v56, v4
    v_dot2c_f32_bf16 v7, v57, v4
    v_dot2c_f32_bf16 v8, v58, v4
    v_dot2c_f32_bf16 v9, v59, v4
    s_waitcnt vmcnt(8)
    v_dot2c_f32_bf16 v6, v60, v4
    v_dot2c_f32_bf16 v7, v61, v4
    v_dot2c_f32_bf16 v8, v62, v4
    v_dot2c_f32_bf16 v9, v63, v4
    s_nop 2
    v_add_f32 v6, v6, v7
    v_add_f32 v8, v8, v9
    v_add_f32 v6, v6, v8
    s_nop 1
    v_add_f32_dpp v6, v6, v6 row_shr:1 row_mask:0xf bank_mask:0xf bound_ctrl:0
    s_nop 1
    v_add_f32_dpp v6, v6, v6 row_shr:2 row_mask:0xf bank_mask:0xf bound_ctrl:0
    s_nop 1
    v_add_f32_dpp v6, v6, v6 row_shr:4 row_mask:0xf bank_mask:0xf bound_ctrl:0
    s_nop 1
    v_add_f32_dpp v6, v6, v6 row_shr:8 row_mask:0xf bank_mask:0xf bound_ctrl:0
    s_nop 1
    v_add_f32_dpp v6, v6, v6 row_bcast:15 row_mask:0xa bank_mask:0xf
    s_nop 1
    v_add_f32_dpp v6, v6, v6 row_bcast:31 row_mask:0xc bank_mask:0xf
    s_mov_b64 exec, s[28:29]
    ds_write_b32 v2, v6 offset:0
    s_mov_b64 exec, -1
    s_waitcnt lgkmcnt(0)
    s_barrier
    ds_read_b128 v[16:19], v3 offset:0
    ds_read_b128 v[20:23], v3 offset:16
    ds_read_b128 v[24:27], v3 offset:32
    ds_read_b128 v[28:31], v3 offset:48
    s_waitcnt lgkmcnt(0)
    v_pk_add_f32 v[16:17], v[16:17], v[24:25]
    v_pk_add_f32 v[18:19], v[18:19], v[26:27]
    v_pk_add_f32 v[20:21], v[20:21], v[28:29]
    v_pk_add_f32 v[22:23], v[22:23], v[30:31]
    v_pk_add_f32 v[16:17], v[16:17], v[20:21]
    v_pk_add_f32 v[18:19], v[18:19], v[22:23]
    v_pk_add_f32 v[16:17], v[16:17], v[18:19]
    v_add_f32 v16, v16, v17
    buffer_load_dwordx4 v[96:99], v1, s[16:19], s36 offen offset:0 nt
    buffer_load_dwordx4 v[100:103], v1, s[16:19], s36 offen offset:1024 nt
    buffer_load_dwordx4 v[104:107], v1, s[16:19], s36 offen offset:2048 nt
    buffer_load_dwordx4 v[108:111], v1, s[16:19], s36 offen offset:3072 nt
    buffer_load_dwordx4 v[112:115], v1, s[16:19], s37 offen offset:0 nt
    buffer_load_dwordx4 v[116:119], v1, s[16:19], s37 offen offset:1024 nt
    buffer_load_dwordx4 v[120:123], v1, s[16:19], s37 offen offset:2048 nt
    buffer_load_dwordx4 v[124:127], v1, s[16:19], s37 offen offset:3072 nt
    v_mul_f32 v10, 0x37800000, v16
    v_cvt_pk_bf16_f32 v10, v10, v10
    v_and_b32 v10, 0xffff0000, v10
    v_xor_b32 v10, 0x80000000, v10
    v_mov_b32 v6, 0
    v_mov_b32 v7, 0
    v_mov_b32 v8, 0
    v_mov_b32 v9, 0
    v_lshlrev_b32 v16, 16, v32
    v_and_b32 v17, 0xffff0000, v32
    v_pk_add_f32 v[16:17], v[16:17], v[10:11] op_sel_hi:[1,0]
    v_pk_fma_f32 v[6:7], v[16:17], v[16:17], v[6:7]
    v_lshlrev_b32 v18, 16, v33
    v_and_b32 v19, 0xffff0000, v33
    v_pk_add_f32 v[18:19], v[18:19], v[10:11] op_sel_hi:[1,0]
    v_pk_fma_f32 v[8:9], v[18:19], v[18:19], v[8:9]
    v_lshlrev_b32 v20, 16, v34
    v_and_b32 v21, 0xffff0000, v34
    v_pk_add_f32 v[20:21], v[20:21], v[10:11] op_sel_hi:[1,0]
    v_pk_fma_f32 v[6:7], v[20:21], v[20:21], v[6:7]
    v_lshlrev_b32 v22, 16, v35
    v_and_b32 v23, 0xffff0000, v35
    v_pk_add_f32 v[22:23], v[22:23], v[10:11] op_sel_hi:[1,0]
    v_pk_fma_f32 v[8:9], v[22:23], v[22:23], v[8:9]
    v_lshlrev_b32 v24, 16, v36
    v_and_b32 v25, 0xffff0000, v36
    v_pk_add_f32 v[24:25], v[24:25], v[10:11] op_sel_hi:[1,0]
    v_pk_fma_f32 v[6:7], v[24:25], v[24:25], v[6:7]
    v_lshlrev_b32 v26, 16, v37
    v_and_b32 v27, 0xffff0000, v37
    v_pk_add_f32 v[26:27], v[26:27], v[10:11] op_sel_hi:[1,0]
    v_pk_fma_f32 v[8:9], v[26:27], v[26:27], v[8:9]
    v_lshlrev_b32 v28, 16, v38
    v_and_b32 v29, 0xffff0000, v38
    v_pk_add_f32 v[28:29], v[28:29], v[10:11] op_sel_hi:[1,0]
    v_pk_fma_f32 v[6:7], v[28:29], v[28:29], v[6:7]
    v_lshlrev_b32 v30, 16, v39
    v_and_b32 v31, 0xffff0000, v39
    v_pk_add_f32 v[30:31], v[30:31], v[10:11] op_sel_hi:[1,0]
    v_pk_fma_f32 v[8:9], v[30:31], v[30:31], v[8:9]
    v_lshlrev_b32 v16, 16, v40
    v_and_b32 v17, 0xffff0000, v40
    v_pk_add_f32 v[16:17], v[16:17], v[10:11] op_sel_hi:[1,0]
    v_pk_fma_f32 v[6:7], v[16:17], v[16:17], v[6:7]
    v_lshlrev_b32 v18, 16, v41
    v_and_b32 v19, 0xffff0000, v41
    v_pk_add_f32 v[18:19], v[18:19], v[10:11] op_sel_hi:[1,0]
    v_pk_fma_f32 v[8:9], v[18:19], v[18:19], v[8:9]
    v_lshlrev_b32 v20, 16, v42
    v_and_b32 v21, 0xffff0000, v42
    v_pk_add_f32 v[20:21], v[20:21], v[10:11] op_sel_hi:[1,0]
    v_pk_fma_f32 v[6:7], v[20:21], v[20:21], v[6:7]
    v_lshlrev_b32 v22, 16, v43
    v_and_b32 v23, 0xffff0000, v43
    v_pk_add_f32 v[22:23], v[22:23], v[10:11] op_sel_hi:[1,0]
    v_pk_fma_f32 v[8:9], v[22:23], v[22:23], v[8:9]
    v_lshlrev_b32 v24, 16, v44
    v_and_b32 v25, 0xffff0000, v44
    v_pk_add_f32 v[24:25], v[24:25], v[10:11] op_sel_hi:[1,0]
    v_pk_fma_f32 v[6:7], v[24:25], v[24:25], v[6:7]
    v_lshlrev_b32 v26, 16, v45
    v_and_b32 v27, 0xffff0000, v45
    v_pk_add_f32 v[26:27], v[26:27], v[10:11] op_sel_hi:[1,0]
    v_pk_fma_f32 v[8:9], v[26:27], v[26:27], v[8:9]
    v_lshlrev_b32 v28, 16, v46
    v_and_b32 v29, 0xffff0000, v46
    v_pk_add_f32 v[28:29], v[28:29], v[10:11] op_sel_hi:[1,0]
    v_pk_fma_f32 v[6:7], v[28:29], v[28:29], v[6:7]
    v_lshlrev_b32 v30, 16, v47
    v_and_b32 v31, 0xffff0000, v47
    v_pk_add_f32 v[30:31], v[30:31], v[10:11] op_sel_hi:[1,0]
    v_pk_fma_f32 v[8:9], v[30:31], v[30:31], v[8:9]
    v_lshlrev_b32 v16, 16, v48
    v_and_b32 v17, 0xffff0000, v48
    v_pk_add_f32 v[16:17], v[16:17], v[10:11] op_sel_hi:[1,0]
    v_pk_fma_f32 v[6:7], v[16:17], v[16:17], v[6:7]
    v_lshlrev_b32 v18, 16, v49
    v_and_b32 v19, 0xffff0000, v49
    v_pk_add_f32 v[18:19], v[18:19], v[10:11] op_sel_hi:[1,0]
    v_pk_fma_f32 v[8:9], v[18:19], v[18:19], v[8:9]
    v_lshlrev_b32 v20, 16, v50
    v_and_b32 v21, 0xffff0000, v50
    v_pk_add_f32 v[20:21], v[20:21], v[10:11] op_sel_hi:[1,0]
    v_pk_fma_f32 v[6:7], v[20:21], v[20:21], v[6:7]
    v_lshlrev_b32 v22, 16, v51
    v_and_b32 v23, 0xffff0000, v51
    v_pk_add_f32 v[22:23], v[22:23], v[10:11] op_sel_hi:[1,0]
    v_pk_fma_f32 v[8:9], v[22:23], v[22:23], v[8:9]
    v_lshlrev_b32 v24, 16, v52
    v_and_b32 v25, 0xffff0000, v52
    v_pk_add_f32 v[24:25], v[24:25], v[10:11] op_sel_hi:[1,0]
    v_pk_fma_f32 v[6:7], v[24:25], v[24:25], v[6:7]
    v_lshlrev_b32 v26, 16, v53
    v_and_b32 v27, 0xffff0000, v53
    v_pk_add_f32 v[26:27], v[26:27], v[10:11] op_sel_hi:[1,0]
    v_pk_fma_f32 v[8:9], v[26:27], v[26:27], v[8:9]
    v_lshlrev_b32 v28, 16, v54
    v_and_b32 v29, 0xffff0000, v54
    v_pk_add_f32 v[28:29], v[28:29], v[10:11] op_sel_hi:[1,0]
    v_pk_fma_f32 v[6:7], v[28:29], v[28:29], v[6:7]
    v_lshlrev_b32 v30, 16, v55
    v_and_b32 v31, 0xffff0000, v55
    v_pk_add_f32 v[30:31], v[30:31], v[10:11] op_sel_hi:[1,0]
    v_pk_fma_f32 v[8:9], v[30:31], v[30:31], v[8:9]
    v_lshlrev_b32 v16, 16, v56
    v_and_b32 v17, 0xffff0000, v56
    v_pk_add_f32 v[16:17], v[16:17], v[10:11] op_sel_hi:[1,0]
    v_pk_fma_f32 v[6:7], v[16:17], v[16:17], v[6:7]
    v_lshlrev_b32 v18, 16, v57
    v_and_b32 v19, 0xffff0000, v57
    v_pk_add_f32 v[18:19], v[18:19], v[10:11] op_sel_hi:[1,0]
    v_pk_fma_f32 v[8:9], v[18:19], v[18:19], v[8:9]
    v_lshlrev_b32 v20, 16, v58
    v_and_b32 v21, 0xffff0000, v58
    v_pk_add_f32 v[20:21], v[20:21], v[10:11] op_sel_hi:[1,0]
    v_pk_fma_f32 v[6:7], v[20:21], v[20:21], v[6:7]
    v_lshlrev_b32 v22, 16, v59
    v_and_b32 v23, 0xffff0000, v59
    v_pk_add_f32 v[22:23], v[22:23], v[10:11] op_sel_hi:[1,0]
    v_pk_fma_f32 v[8:9], v[22:23], v[22:23], v[8:9]
    v_lshlrev_b32 v24, 16, v60
    v_and_b32 v25, 0xffff0000, v60
    v_pk_add_f32 v[24:25], v[24:25], v[10:11] op_sel_hi:[1,0]
    v_pk_fma_f32 v[6:7], v[24:25], v[24:25], v[6:7]
    v_lshlrev_b32 v26, 16, v61
    v_and_b32 v27, 0xffff0000, v61
    v_pk_add_f32 v[26:27], v[26:27], v[10:11] op_sel_hi:[1,0]
    v_pk_fma_f32 v[8:9], v[26:27], v[26:27], v[8:9]
    v_lshlrev_b32 v28, 16, v62
    v_and_b32 v29, 0xffff0000, v62
    v_pk_add_f32 v[28:29], v[28:29], v[10:11] op_sel_hi:[1,0]
    v_pk_fma_f32 v[6:7], v[28:29], v[28:29], v[6:7]
    v_lshlrev_b32 v30, 16, v63
    v_and_b32 v31, 0xffff0000, v63
    v_pk_add_f32 v[30:31], v[30:31], v[10:11] op_sel_hi:[1,0]
    v_pk_fma_f32 v[8:9], v[30:31], v[30:31], v[8:9]
    v_pk_add_f32 v[6:7], v[6:7], v[8:9]
    v_add_f32 v6, v6, v7
    s_nop 1
    v_add_f32_dpp v6, v6, v6 row_shr:1 row_mask:0xf bank_mask:0xf bound_ctrl:0
    s_nop 1
    v_add_f32_dpp v6, v6, v6 row_shr:2 row_mask:0xf bank_mask:0xf bound_ctrl:0
    s_nop 1
    v_add_f32_dpp v6, v6, v6 row_shr:4 row_mask:0xf bank_mask:0xf bound_ctrl:0
    s_nop 1
    v_add_f32_dpp v6, v6, v6 row_shr:8 row_mask:0xf bank_mask:0xf bound_ctrl:0
    s_nop 1
    v_add_f32_dpp v6, v6, v6 row_bcast:15 row_mask:0xa bank_mask:0xf
    s_nop 1
    v_add_f32_dpp v6, v6, v6 row_bcast:31 row_mask:0xc bank_mask:0xf
    s_mov_b64 exec, s[28:29]
    ds_write_b32 v2, v6 offset:64
    s_mov_b64 exec, -1
    s_waitcnt lgkmcnt(0)
    s_barrier
    ds_read_b128 v[16:19], v3 offset:64
    ds_read_b128 v[20:23], v3 offset:80
    ds_read_b128 v[24:27], v3 offset:96
    ds_read_b128 v[28:31], v3 offset:112
    s_waitcnt lgkmcnt(0)
    v_pk_add_f32 v[16:17], v[16:17], v[24:25]
    v_pk_add_f32 v[18:19], v[18:19], v[26:27]
    v_pk_add_f32 v[20:21], v[20:21], v[28:29]
    v_pk_add_f32 v[22:23], v[22:23], v[30:31]
    v_pk_add_f32 v[16:17], v[16:17], v[20:21]
    v_pk_add_f32 v[18:19], v[18:19], v[22:23]
    v_pk_add_f32 v[16:17], v[16:17], v[18:19]
    v_add_f32 v16, v16, v17
    s_and_b32 s30, s56, 1
    s_lshl_b32 s31, s44, 16
    s_and_b32 s24, s44, s27
    s_cmp_eq_u32 s30, 1
    s_cselect_b32 s24, s24, s31
    s_lshl_b32 s31, s50, 16
    s_and_b32 s25, s50, s27
    s_cmp_eq_u32 s30, 1
    s_cselect_b32 s25, s25, s31
    v_mul_f32 v17, 0x37800000, v16
    v_cvt_pk_bf16_f32 v17, v17, v17
    v_and_b32 v17, 0xffff0000, v17
    v_add_f32 v17, 0x3727c5ac, v17
    v_cvt_pk_bf16_f32 v17, v17, v17
    v_and_b32 v17, 0xffff0000, v17
    v_sqrt_f32 v17, v17
    s_nop 0
    v_cvt_pk_bf16_f32 v17, v17, v17
    v_and_b32 v17, 0xffff0000, v17
    v_rcp_f32 v12, v17
    s_nop 0
    v_fma_f32 v18, -v17, v12, 1.0
    v_fma_f32 v12, v18, v12, v12
    v_mul_f32 v12, s24, v12
    v_mov_b32 v14, s25
    v_fma_f32 v14, v10, v12, v14
    v_lshlrev_b32 v16, 16, v32
    v_and_b32 v17, 0xffff0000, v32
    v_pk_fma_f32 v[16:17], v[16:17], v[12:13], v[14:15] op_sel_hi:[1,0,0]
    v_cvt_pk_bf16_f32 v32, v16, v17
    v_lshlrev_b32 v18, 16, v33
    v_and_b32 v19, 0xffff0000, v33
    v_pk_fma_f32 v[18:19], v[18:19], v[12:13], v[14:15] op_sel_hi:[1,0,0]
    v_cvt_pk_bf16_f32 v33, v18, v19
    v_lshlrev_b32 v20, 16, v34
    v_and_b32 v21, 0xffff0000, v34
    v_pk_fma_f32 v[20:21], v[20:21], v[12:13], v[14:15] op_sel_hi:[1,0,0]
    v_cvt_pk_bf16_f32 v34, v20, v21
    v_lshlrev_b32 v22, 16, v35
    v_and_b32 v23, 0xffff0000, v35
    v_pk_fma_f32 v[22:23], v[22:23], v[12:13], v[14:15] op_sel_hi:[1,0,0]
    v_cvt_pk_bf16_f32 v35, v22, v23
    v_lshlrev_b32 v24, 16, v36
    v_and_b32 v25, 0xffff0000, v36
    v_pk_fma_f32 v[24:25], v[24:25], v[12:13], v[14:15] op_sel_hi:[1,0,0]
    v_cvt_pk_bf16_f32 v36, v24, v25
    v_lshlrev_b32 v26, 16, v37
    v_and_b32 v27, 0xffff0000, v37
    v_pk_fma_f32 v[26:27], v[26:27], v[12:13], v[14:15] op_sel_hi:[1,0,0]
    v_cvt_pk_bf16_f32 v37, v26, v27
    v_lshlrev_b32 v28, 16, v38
    v_and_b32 v29, 0xffff0000, v38
    v_pk_fma_f32 v[28:29], v[28:29], v[12:13], v[14:15] op_sel_hi:[1,0,0]
    v_cvt_pk_bf16_f32 v38, v28, v29
    v_lshlrev_b32 v30, 16, v39
    v_and_b32 v31, 0xffff0000, v39
    v_pk_fma_f32 v[30:31], v[30:31], v[12:13], v[14:15] op_sel_hi:[1,0,0]
    v_cvt_pk_bf16_f32 v39, v30, v31
    v_lshlrev_b32 v16, 16, v40
    v_and_b32 v17, 0xffff0000, v40
    v_pk_fma_f32 v[16:17], v[16:17], v[12:13], v[14:15] op_sel_hi:[1,0,0]
    v_cvt_pk_bf16_f32 v40, v16, v17
    v_lshlrev_b32 v18, 16, v41
    v_and_b32 v19, 0xffff0000, v41
    v_pk_fma_f32 v[18:19], v[18:19], v[12:13], v[14:15] op_sel_hi:[1,0,0]
    v_cvt_pk_bf16_f32 v41, v18, v19
    v_lshlrev_b32 v20, 16, v42
    v_and_b32 v21, 0xffff0000, v42
    v_pk_fma_f32 v[20:21], v[20:21], v[12:13], v[14:15] op_sel_hi:[1,0,0]
    v_cvt_pk_bf16_f32 v42, v20, v21
    v_lshlrev_b32 v22, 16, v43
    v_and_b32 v23, 0xffff0000, v43
    v_pk_fma_f32 v[22:23], v[22:23], v[12:13], v[14:15] op_sel_hi:[1,0,0]
    v_cvt_pk_bf16_f32 v43, v22, v23
    v_lshlrev_b32 v24, 16, v44
    v_and_b32 v25, 0xffff0000, v44
    v_pk_fma_f32 v[24:25], v[24:25], v[12:13], v[14:15] op_sel_hi:[1,0,0]
    v_cvt_pk_bf16_f32 v44, v24, v25
    v_lshlrev_b32 v26, 16, v45
    v_and_b32 v27, 0xffff0000, v45
    v_pk_fma_f32 v[26:27], v[26:27], v[12:13], v[14:15] op_sel_hi:[1,0,0]
    v_cvt_pk_bf16_f32 v45, v26, v27
    v_lshlrev_b32 v28, 16, v46
    v_and_b32 v29, 0xffff0000, v46
    v_pk_fma_f32 v[28:29], v[28:29], v[12:13], v[14:15] op_sel_hi:[1,0,0]
    v_cvt_pk_bf16_f32 v46, v28, v29
    v_lshlrev_b32 v30, 16, v47
    v_and_b32 v31, 0xffff0000, v47
    v_pk_fma_f32 v[30:31], v[30:31], v[12:13], v[14:15] op_sel_hi:[1,0,0]
    v_cvt_pk_bf16_f32 v47, v30, v31
    v_lshlrev_b32 v16, 16, v48
    v_and_b32 v17, 0xffff0000, v48
    v_pk_fma_f32 v[16:17], v[16:17], v[12:13], v[14:15] op_sel_hi:[1,0,0]
    v_cvt_pk_bf16_f32 v48, v16, v17
    v_lshlrev_b32 v18, 16, v49
    v_and_b32 v19, 0xffff0000, v49
    v_pk_fma_f32 v[18:19], v[18:19], v[12:13], v[14:15] op_sel_hi:[1,0,0]
    v_cvt_pk_bf16_f32 v49, v18, v19
    v_lshlrev_b32 v20, 16, v50
    v_and_b32 v21, 0xffff0000, v50
    v_pk_fma_f32 v[20:21], v[20:21], v[12:13], v[14:15] op_sel_hi:[1,0,0]
    v_cvt_pk_bf16_f32 v50, v20, v21
    v_lshlrev_b32 v22, 16, v51
    v_and_b32 v23, 0xffff0000, v51
    v_pk_fma_f32 v[22:23], v[22:23], v[12:13], v[14:15] op_sel_hi:[1,0,0]
    v_cvt_pk_bf16_f32 v51, v22, v23
    v_lshlrev_b32 v24, 16, v52
    v_and_b32 v25, 0xffff0000, v52
    v_pk_fma_f32 v[24:25], v[24:25], v[12:13], v[14:15] op_sel_hi:[1,0,0]
    v_cvt_pk_bf16_f32 v52, v24, v25
    v_lshlrev_b32 v26, 16, v53
    v_and_b32 v27, 0xffff0000, v53
    v_pk_fma_f32 v[26:27], v[26:27], v[12:13], v[14:15] op_sel_hi:[1,0,0]
    v_cvt_pk_bf16_f32 v53, v26, v27
    v_lshlrev_b32 v28, 16, v54
    v_and_b32 v29, 0xffff0000, v54
    v_pk_fma_f32 v[28:29], v[28:29], v[12:13], v[14:15] op_sel_hi:[1,0,0]
    v_cvt_pk_bf16_f32 v54, v28, v29
    v_lshlrev_b32 v30, 16, v55
    v_and_b32 v31, 0xffff0000, v55
    v_pk_fma_f32 v[30:31], v[30:31], v[12:13], v[14:15] op_sel_hi:[1,0,0]
    v_cvt_pk_bf16_f32 v55, v30, v31
    v_lshlrev_b32 v16, 16, v56
    v_and_b32 v17, 0xffff0000, v56
    v_pk_fma_f32 v[16:17], v[16:17], v[12:13], v[14:15] op_sel_hi:[1,0,0]
    v_cvt_pk_bf16_f32 v56, v16, v17
    v_lshlrev_b32 v18, 16, v57
    v_and_b32 v19, 0xffff0000, v57
    v_pk_fma_f32 v[18:19], v[18:19], v[12:13], v[14:15] op_sel_hi:[1,0,0]
    v_cvt_pk_bf16_f32 v57, v18, v19
    v_lshlrev_b32 v20, 16, v58
    v_and_b32 v21, 0xffff0000, v58
    v_pk_fma_f32 v[20:21], v[20:21], v[12:13], v[14:15] op_sel_hi:[1,0,0]
    v_cvt_pk_bf16_f32 v58, v20, v21
    v_lshlrev_b32 v22, 16, v59
    v_and_b32 v23, 0xffff0000, v59
    v_pk_fma_f32 v[22:23], v[22:23], v[12:13], v[14:15] op_sel_hi:[1,0,0]
    v_cvt_pk_bf16_f32 v59, v22, v23
    v_lshlrev_b32 v24, 16, v60
    v_and_b32 v25, 0xffff0000, v60
    v_pk_fma_f32 v[24:25], v[24:25], v[12:13], v[14:15] op_sel_hi:[1,0,0]
    v_cvt_pk_bf16_f32 v60, v24, v25
    v_lshlrev_b32 v26, 16, v61
    v_and_b32 v27, 0xffff0000, v61
    v_pk_fma_f32 v[26:27], v[26:27], v[12:13], v[14:15] op_sel_hi:[1,0,0]
    v_cvt_pk_bf16_f32 v61, v26, v27
    v_lshlrev_b32 v28, 16, v62
    v_and_b32 v29, 0xffff0000, v62
    v_pk_fma_f32 v[28:29], v[28:29], v[12:13], v[14:15] op_sel_hi:[1,0,0]
    v_cvt_pk_bf16_f32 v62, v28, v29
    v_lshlrev_b32 v30, 16, v63
    v_and_b32 v31, 0xffff0000, v63
    v_pk_fma_f32 v[30:31], v[30:31], v[12:13], v[14:15] op_sel_hi:[1,0,0]
    v_cvt_pk_bf16_f32 v63, v30, v31
    buffer_store_dwordx4 v[32:35], v1, s[20:23], s32 offen offset:0
    buffer_store_dwordx4 v[36:39], v1, s[20:23], s32 offen offset:1024
    buffer_store_dwordx4 v[40:43], v1, s[20:23], s32 offen offset:2048
    buffer_store_dwordx4 v[44:47], v1, s[20:23], s32 offen offset:3072
    buffer_store_dwordx4 v[48:51], v1, s[20:23], s33 offen offset:0
    buffer_store_dwordx4 v[52:55], v1, s[20:23], s33 offen offset:1024
    buffer_store_dwordx4 v[56:59], v1, s[20:23], s33 offen offset:2048
    buffer_store_dwordx4 v[60:63], v1, s[20:23], s33 offen offset:3072
    s_nop 1
    buffer_load_dwordx4 v[32:35], v1, s[16:19], s38 offen offset:0 nt
    buffer_load_dwordx4 v[36:39], v1, s[16:19], s38 offen offset:1024 nt
    buffer_load_dwordx4 v[40:43], v1, s[16:19], s38 offen offset:2048 nt
    buffer_load_dwordx4 v[44:47], v1, s[16:19], s38 offen offset:3072 nt
    buffer_load_dwordx4 v[48:51], v1, s[16:19], s39 offen offset:0 nt
    buffer_load_dwordx4 v[52:55], v1, s[16:19], s39 offen offset:1024 nt
    buffer_load_dwordx4 v[56:59], v1, s[16:19], s39 offen offset:2048 nt
    buffer_load_dwordx4 v[60:63], v1, s[16:19], s39 offen offset:3072 nt
    v_mov_b32 v6, 0
    v_mov_b32 v7, 0
    v_mov_b32 v8, 0
    v_mov_b32 v9, 0
    s_waitcnt vmcnt(31)
    v_dot2c_f32_bf16 v6, v64, v4
    v_dot2c_f32_bf16 v7, v65, v4
    v_dot2c_f32_bf16 v8, v66, v4
    v_dot2c_f32_bf16 v9, v67, v4
    s_waitcnt vmcnt(30)
    v_dot2c_f32_bf16 v6, v68, v4
    v_dot2c_f32_bf16 v7, v69, v4
    v_dot2c_f32_bf16 v8, v70, v4
    v_dot2c_f32_bf16 v9, v71, v4
    s_waitcnt vmcnt(29)
    v_dot2c_f32_bf16 v6, v72, v4
    v_dot2c_f32_bf16 v7, v73, v4
    v_dot2c_f32_bf16 v8, v74, v4
    v_dot2c_f32_bf16 v9, v75, v4
    s_waitcnt vmcnt(28)
    v_dot2c_f32_bf16 v6, v76, v4
    v_dot2c_f32_bf16 v7, v77, v4
    v_dot2c_f32_bf16 v8, v78, v4
    v_dot2c_f32_bf16 v9, v79, v4
    s_waitcnt vmcnt(27)
    v_dot2c_f32_bf16 v6, v80, v4
    v_dot2c_f32_bf16 v7, v81, v4
    v_dot2c_f32_bf16 v8, v82, v4
    v_dot2c_f32_bf16 v9, v83, v4
    s_waitcnt vmcnt(26)
    v_dot2c_f32_bf16 v6, v84, v4
    v_dot2c_f32_bf16 v7, v85, v4
    v_dot2c_f32_bf16 v8, v86, v4
    v_dot2c_f32_bf16 v9, v87, v4
    s_waitcnt vmcnt(25)
    v_dot2c_f32_bf16 v6, v88, v4
    v_dot2c_f32_bf16 v7, v89, v4
    v_dot2c_f32_bf16 v8, v90, v4
    v_dot2c_f32_bf16 v9, v91, v4
    s_waitcnt vmcnt(24)
    v_dot2c_f32_bf16 v6, v92, v4
    v_dot2c_f32_bf16 v7, v93, v4
    v_dot2c_f32_bf16 v8, v94, v4
    v_dot2c_f32_bf16 v9, v95, v4
    s_nop 2
    v_add_f32 v6, v6, v7
    v_add_f32 v8, v8, v9
    v_add_f32 v6, v6, v8
    s_nop 1
    v_add_f32_dpp v6, v6, v6 row_shr:1 row_mask:0xf bank_mask:0xf bound_ctrl:0
    s_nop 1
    v_add_f32_dpp v6, v6, v6 row_shr:2 row_mask:0xf bank_mask:0xf bound_ctrl:0
    s_nop 1
    v_add_f32_dpp v6, v6, v6 row_shr:4 row_mask:0xf bank_mask:0xf bound_ctrl:0
    s_nop 1
    v_add_f32_dpp v6, v6, v6 row_shr:8 row_mask:0xf bank_mask:0xf bound_ctrl:0
    s_nop 1
    v_add_f32_dpp v6, v6, v6 row_bcast:15 row_mask:0xa bank_mask:0xf
    s_nop 1
    v_add_f32_dpp v6, v6, v6 row_bcast:31 row_mask:0xc bank_mask:0xf
    s_mov_b64 exec, s[28:29]
    ds_write_b32 v2, v6 offset:256
    s_mov_b64 exec, -1
    s_waitcnt lgkmcnt(0)
    s_barrier
    ds_read_b128 v[16:19], v3 offset:256
    ds_read_b128 v[20:23], v3 offset:272
    ds_read_b128 v[24:27], v3 offset:288
    ds_read_b128 v[28:31], v3 offset:304
    s_waitcnt lgkmcnt(0)
    v_pk_add_f32 v[16:17], v[16:17], v[24:25]
    v_pk_add_f32 v[18:19], v[18:19], v[26:27]
    v_pk_add_f32 v[20:21], v[20:21], v[28:29]
    v_pk_add_f32 v[22:23], v[22:23], v[30:31]
    v_pk_add_f32 v[16:17], v[16:17], v[20:21]
    v_pk_add_f32 v[18:19], v[18:19], v[22:23]
    v_pk_add_f32 v[16:17], v[16:17], v[18:19]
    v_add_f32 v16, v16, v17
    v_mul_f32 v10, 0x37800000, v16
    v_cvt_pk_bf16_f32 v10, v10, v10
    v_and_b32 v10, 0xffff0000, v10
    v_xor_b32 v10, 0x80000000, v10
    v_mov_b32 v6, 0
    v_mov_b32 v7, 0
    v_mov_b32 v8, 0
    v_mov_b32 v9, 0
    v_lshlrev_b32 v16, 16, v64
    v_and_b32 v17, 0xffff0000, v64
    v_pk_add_f32 v[16:17], v[16:17], v[10:11] op_sel_hi:[1,0]
    v_pk_fma_f32 v[6:7], v[16:17], v[16:17], v[6:7]
    v_lshlrev_b32 v18, 16, v65
    v_and_b32 v19, 0xffff0000, v65
    v_pk_add_f32 v[18:19], v[18:19], v[10:11] op_sel_hi:[1,0]
    v_pk_fma_f32 v[8:9], v[18:19], v[18:19], v[8:9]
    v_lshlrev_b32 v20, 16, v66
    v_and_b32 v21, 0xffff0000, v66
    v_pk_add_f32 v[20:21], v[20:21], v[10:11] op_sel_hi:[1,0]
    v_pk_fma_f32 v[6:7], v[20:21], v[20:21], v[6:7]
    v_lshlrev_b32 v22, 16, v67
    v_and_b32 v23, 0xffff0000, v67
    v_pk_add_f32 v[22:23], v[22:23], v[10:11] op_sel_hi:[1,0]
    v_pk_fma_f32 v[8:9], v[22:23], v[22:23], v[8:9]
    v_lshlrev_b32 v24, 16, v68
    v_and_b32 v25, 0xffff0000, v68
    v_pk_add_f32 v[24:25], v[24:25], v[10:11] op_sel_hi:[1,0]
    v_pk_fma_f32 v[6:7], v[24:25], v[24:25], v[6:7]
    v_lshlrev_b32 v26, 16, v69
    v_and_b32 v27, 0xffff0000, v69
    v_pk_add_f32 v[26:27], v[26:27], v[10:11] op_sel_hi:[1,0]
    v_pk_fma_f32 v[8:9], v[26:27], v[26:27], v[8:9]
    v_lshlrev_b32 v28, 16, v70
    v_and_b32 v29, 0xffff0000, v70
    v_pk_add_f32 v[28:29], v[28:29], v[10:11] op_sel_hi:[1,0]
    v_pk_fma_f32 v[6:7], v[28:29], v[28:29], v[6:7]
    v_lshlrev_b32 v30, 16, v71
    v_and_b32 v31, 0xffff0000, v71
    v_pk_add_f32 v[30:31], v[30:31], v[10:11] op_sel_hi:[1,0]
    v_pk_fma_f32 v[8:9], v[30:31], v[30:31], v[8:9]
    v_lshlrev_b32 v16, 16, v72
    v_and_b32 v17, 0xffff0000, v72
    v_pk_add_f32 v[16:17], v[16:17], v[10:11] op_sel_hi:[1,0]
    v_pk_fma_f32 v[6:7], v[16:17], v[16:17], v[6:7]
    v_lshlrev_b32 v18, 16, v73
    v_and_b32 v19, 0xffff0000, v73
    v_pk_add_f32 v[18:19], v[18:19], v[10:11] op_sel_hi:[1,0]
    v_pk_fma_f32 v[8:9], v[18:19], v[18:19], v[8:9]
    v_lshlrev_b32 v20, 16, v74
    v_and_b32 v21, 0xffff0000, v74
    v_pk_add_f32 v[20:21], v[20:21], v[10:11] op_sel_hi:[1,0]
    v_pk_fma_f32 v[6:7], v[20:21], v[20:21], v[6:7]
    v_lshlrev_b32 v22, 16, v75
    v_and_b32 v23, 0xffff0000, v75
    v_pk_add_f32 v[22:23], v[22:23], v[10:11] op_sel_hi:[1,0]
    v_pk_fma_f32 v[8:9], v[22:23], v[22:23], v[8:9]
    v_lshlrev_b32 v24, 16, v76
    v_and_b32 v25, 0xffff0000, v76
    v_pk_add_f32 v[24:25], v[24:25], v[10:11] op_sel_hi:[1,0]
    v_pk_fma_f32 v[6:7], v[24:25], v[24:25], v[6:7]
    v_lshlrev_b32 v26, 16, v77
    v_and_b32 v27, 0xffff0000, v77
    v_pk_add_f32 v[26:27], v[26:27], v[10:11] op_sel_hi:[1,0]
    v_pk_fma_f32 v[8:9], v[26:27], v[26:27], v[8:9]
    v_lshlrev_b32 v28, 16, v78
    v_and_b32 v29, 0xffff0000, v78
    v_pk_add_f32 v[28:29], v[28:29], v[10:11] op_sel_hi:[1,0]
    v_pk_fma_f32 v[6:7], v[28:29], v[28:29], v[6:7]
    v_lshlrev_b32 v30, 16, v79
    v_and_b32 v31, 0xffff0000, v79
    v_pk_add_f32 v[30:31], v[30:31], v[10:11] op_sel_hi:[1,0]
    v_pk_fma_f32 v[8:9], v[30:31], v[30:31], v[8:9]
    v_lshlrev_b32 v16, 16, v80
    v_and_b32 v17, 0xffff0000, v80
    v_pk_add_f32 v[16:17], v[16:17], v[10:11] op_sel_hi:[1,0]
    v_pk_fma_f32 v[6:7], v[16:17], v[16:17], v[6:7]
    v_lshlrev_b32 v18, 16, v81
    v_and_b32 v19, 0xffff0000, v81
    v_pk_add_f32 v[18:19], v[18:19], v[10:11] op_sel_hi:[1,0]
    v_pk_fma_f32 v[8:9], v[18:19], v[18:19], v[8:9]
    v_lshlrev_b32 v20, 16, v82
    v_and_b32 v21, 0xffff0000, v82
    v_pk_add_f32 v[20:21], v[20:21], v[10:11] op_sel_hi:[1,0]
    v_pk_fma_f32 v[6:7], v[20:21], v[20:21], v[6:7]
    v_lshlrev_b32 v22, 16, v83
    v_and_b32 v23, 0xffff0000, v83
    v_pk_add_f32 v[22:23], v[22:23], v[10:11] op_sel_hi:[1,0]
    v_pk_fma_f32 v[8:9], v[22:23], v[22:23], v[8:9]
    v_lshlrev_b32 v24, 16, v84
    v_and_b32 v25, 0xffff0000, v84
    v_pk_add_f32 v[24:25], v[24:25], v[10:11] op_sel_hi:[1,0]
    v_pk_fma_f32 v[6:7], v[24:25], v[24:25], v[6:7]
    v_lshlrev_b32 v26, 16, v85
    v_and_b32 v27, 0xffff0000, v85
    v_pk_add_f32 v[26:27], v[26:27], v[10:11] op_sel_hi:[1,0]
    v_pk_fma_f32 v[8:9], v[26:27], v[26:27], v[8:9]
    v_lshlrev_b32 v28, 16, v86
    v_and_b32 v29, 0xffff0000, v86
    v_pk_add_f32 v[28:29], v[28:29], v[10:11] op_sel_hi:[1,0]
    v_pk_fma_f32 v[6:7], v[28:29], v[28:29], v[6:7]
    v_lshlrev_b32 v30, 16, v87
    v_and_b32 v31, 0xffff0000, v87
    v_pk_add_f32 v[30:31], v[30:31], v[10:11] op_sel_hi:[1,0]
    v_pk_fma_f32 v[8:9], v[30:31], v[30:31], v[8:9]
    v_lshlrev_b32 v16, 16, v88
    v_and_b32 v17, 0xffff0000, v88
    v_pk_add_f32 v[16:17], v[16:17], v[10:11] op_sel_hi:[1,0]
    v_pk_fma_f32 v[6:7], v[16:17], v[16:17], v[6:7]
    v_lshlrev_b32 v18, 16, v89
    v_and_b32 v19, 0xffff0000, v89
    v_pk_add_f32 v[18:19], v[18:19], v[10:11] op_sel_hi:[1,0]
    v_pk_fma_f32 v[8:9], v[18:19], v[18:19], v[8:9]
    v_lshlrev_b32 v20, 16, v90
    v_and_b32 v21, 0xffff0000, v90
    v_pk_add_f32 v[20:21], v[20:21], v[10:11] op_sel_hi:[1,0]
    v_pk_fma_f32 v[6:7], v[20:21], v[20:21], v[6:7]
    v_lshlrev_b32 v22, 16, v91
    v_and_b32 v23, 0xffff0000, v91
    v_pk_add_f32 v[22:23], v[22:23], v[10:11] op_sel_hi:[1,0]
    v_pk_fma_f32 v[8:9], v[22:23], v[22:23], v[8:9]
    v_lshlrev_b32 v24, 16, v92
    v_and_b32 v25, 0xffff0000, v92
    v_pk_add_f32 v[24:25], v[24:25], v[10:11] op_sel_hi:[1,0]
    v_pk_fma_f32 v[6:7], v[24:25], v[24:25], v[6:7]
    v_lshlrev_b32 v26, 16, v93
    v_and_b32 v27, 0xffff0000, v93
    v_pk_add_f32 v[26:27], v[26:27], v[10:11] op_sel_hi:[1,0]
    v_pk_fma_f32 v[8:9], v[26:27], v[26:27], v[8:9]
    v_lshlrev_b32 v28, 16, v94
    v_and_b32 v29, 0xffff0000, v94
    v_pk_add_f32 v[28:29], v[28:29], v[10:11] op_sel_hi:[1,0]
    v_pk_fma_f32 v[6:7], v[28:29], v[28:29], v[6:7]
    v_lshlrev_b32 v30, 16, v95
    v_and_b32 v31, 0xffff0000, v95
    v_pk_add_f32 v[30:31], v[30:31], v[10:11] op_sel_hi:[1,0]
    v_pk_fma_f32 v[8:9], v[30:31], v[30:31], v[8:9]
    v_pk_add_f32 v[6:7], v[6:7], v[8:9]
    v_add_f32 v6, v6, v7
    s_nop 1
    v_add_f32_dpp v6, v6, v6 row_shr:1 row_mask:0xf bank_mask:0xf bound_ctrl:0
    s_nop 1
    v_add_f32_dpp v6, v6, v6 row_shr:2 row_mask:0xf bank_mask:0xf bound_ctrl:0
    s_nop 1
    v_add_f32_dpp v6, v6, v6 row_shr:4 row_mask:0xf bank_mask:0xf bound_ctrl:0
    s_nop 1
    v_add_f32_dpp v6, v6, v6 row_shr:8 row_mask:0xf bank_mask:0xf bound_ctrl:0
    s_nop 1
    v_add_f32_dpp v6, v6, v6 row_bcast:15 row_mask:0xa bank_mask:0xf
    s_nop 1
    v_add_f32_dpp v6, v6, v6 row_bcast:31 row_mask:0xc bank_mask:0xf
    s_mov_b64 exec, s[28:29]
    ds_write_b32 v2, v6 offset:320
    s_mov_b64 exec, -1
    s_waitcnt lgkmcnt(0)
    s_barrier
    ds_read_b128 v[16:19], v3 offset:320
    ds_read_b128 v[20:23], v3 offset:336
    ds_read_b128 v[24:27], v3 offset:352
    ds_read_b128 v[28:31], v3 offset:368
    s_waitcnt lgkmcnt(0)
    v_pk_add_f32 v[16:17], v[16:17], v[24:25]
    v_pk_add_f32 v[18:19], v[18:19], v[26:27]
    v_pk_add_f32 v[20:21], v[20:21], v[28:29]
    v_pk_add_f32 v[22:23], v[22:23], v[30:31]
    v_pk_add_f32 v[16:17], v[16:17], v[20:21]
    v_pk_add_f32 v[18:19], v[18:19], v[22:23]
    v_pk_add_f32 v[16:17], v[16:17], v[18:19]
    v_add_f32 v16, v16, v17
    s_cmp_lg_u32 s62, 0
    s_cbranch_scc1 L_notk1
    s_mov_b32 s63, 1
    s_atomic_add s63, s[12:13], 0 glc
L_notk1:
    s_and_b32 s30, s57, 1
    s_lshl_b32 s31, s45, 16
    s_and_b32 s24, s45, s27
    s_cmp_eq_u32 s30, 1
    s_cselect_b32 s24, s24, s31
    s_lshl_b32 s31, s51, 16
    s_and_b32 s25, s51, s27
    s_cmp_eq_u32 s30, 1
    s_cselect_b32 s25, s25, s31
    v_mul_f32 v17, 0x37800000, v16
    v_cvt_pk_bf16_f32 v17, v17, v17
    v_and_b32 v17, 0xffff0000, v17
    v_add_f32 v17, 0x3727c5ac, v17
    v_cvt_pk_bf16_f32 v17, v17, v17
    v_and_b32 v17, 0xffff0000, v17
    v_sqrt_f32 v17, v17
    s_nop 0
    v_cvt_pk_bf16_f32 v17, v17, v17
    v_and_b32 v17, 0xffff0000, v17
    v_rcp_f32 v12, v17
    s_nop 0
    v_fma_f32 v18, -v17, v12, 1.0
    v_fma_f32 v12, v18, v12, v12
    v_mul_f32 v12, s24, v12
    v_mov_b32 v14, s25
    v_fma_f32 v14, v10, v12, v14
    v_lshlrev_b32 v16, 16, v64
    v_and_b32 v17, 0xffff0000, v64
    v_pk_fma_f32 v[16:17], v[16:17], v[12:13], v[14:15] op_sel_hi:[1,0,0]
    v_cvt_pk_bf16_f32 v64, v16, v17
    v_lshlrev_b32 v18, 16, v65
    v_and_b32 v19, 0xffff0000, v65
    v_pk_fma_f32 v[18:19], v[18:19], v[12:13], v[14:15] op_sel_hi:[1,0,0]
    v_cvt_pk_bf16_f32 v65, v18, v19
    v_lshlrev_b32 v20, 16, v66
    v_and_b32 v21, 0xffff0000, v66
    v_pk_fma_f32 v[20:21], v[20:21], v[12:13], v[14:15] op_sel_hi:[1,0,0]
    v_cvt_pk_bf16_f32 v66, v20, v21
    v_lshlrev_b32 v22, 16, v67
    v_and_b32 v23, 0xffff0000, v67
    v_pk_fma_f32 v[22:23], v[22:23], v[12:13], v[14:15] op_sel_hi:[1,0,0]
    v_cvt_pk_bf16_f32 v67, v22, v23
    v_lshlrev_b32 v24, 16, v68
    v_and_b32 v25, 0xffff0000, v68
    v_pk_fma_f32 v[24:25], v[24:25], v[12:13], v[14:15] op_sel_hi:[1,0,0]
    v_cvt_pk_bf16_f32 v68, v24, v25
    v_lshlrev_b32 v26, 16, v69
    v_and_b32 v27, 0xffff0000, v69
    v_pk_fma_f32 v[26:27], v[26:27], v[12:13], v[14:15] op_sel_hi:[1,0,0]
    v_cvt_pk_bf16_f32 v69, v26, v27
    v_lshlrev_b32 v28, 16, v70
    v_and_b32 v29, 0xffff0000, v70
    v_pk_fma_f32 v[28:29], v[28:29], v[12:13], v[14:15] op_sel_hi:[1,0,0]
    v_cvt_pk_bf16_f32 v70, v28, v29
    v_lshlrev_b32 v30, 16, v71
    v_and_b32 v31, 0xffff0000, v71
    v_pk_fma_f32 v[30:31], v[30:31], v[12:13], v[14:15] op_sel_hi:[1,0,0]
    v_cvt_pk_bf16_f32 v71, v30, v31
    v_lshlrev_b32 v16, 16, v72
    v_and_b32 v17, 0xffff0000, v72
    v_pk_fma_f32 v[16:17], v[16:17], v[12:13], v[14:15] op_sel_hi:[1,0,0]
    v_cvt_pk_bf16_f32 v72, v16, v17
    v_lshlrev_b32 v18, 16, v73
    v_and_b32 v19, 0xffff0000, v73
    v_pk_fma_f32 v[18:19], v[18:19], v[12:13], v[14:15] op_sel_hi:[1,0,0]
    v_cvt_pk_bf16_f32 v73, v18, v19
    v_lshlrev_b32 v20, 16, v74
    v_and_b32 v21, 0xffff0000, v74
    v_pk_fma_f32 v[20:21], v[20:21], v[12:13], v[14:15] op_sel_hi:[1,0,0]
    v_cvt_pk_bf16_f32 v74, v20, v21
    v_lshlrev_b32 v22, 16, v75
    v_and_b32 v23, 0xffff0000, v75
    v_pk_fma_f32 v[22:23], v[22:23], v[12:13], v[14:15] op_sel_hi:[1,0,0]
    v_cvt_pk_bf16_f32 v75, v22, v23
    v_lshlrev_b32 v24, 16, v76
    v_and_b32 v25, 0xffff0000, v76
    v_pk_fma_f32 v[24:25], v[24:25], v[12:13], v[14:15] op_sel_hi:[1,0,0]
    v_cvt_pk_bf16_f32 v76, v24, v25
    v_lshlrev_b32 v26, 16, v77
    v_and_b32 v27, 0xffff0000, v77
    v_pk_fma_f32 v[26:27], v[26:27], v[12:13], v[14:15] op_sel_hi:[1,0,0]
    v_cvt_pk_bf16_f32 v77, v26, v27
    v_lshlrev_b32 v28, 16, v78
    v_and_b32 v29, 0xffff0000, v78
    v_pk_fma_f32 v[28:29], v[28:29], v[12:13], v[14:15] op_sel_hi:[1,0,0]
    v_cvt_pk_bf16_f32 v78, v28, v29
    v_lshlrev_b32 v30, 16, v79
    v_and_b32 v31, 0xffff0000, v79
    v_pk_fma_f32 v[30:31], v[30:31], v[12:13], v[14:15] op_sel_hi:[1,0,0]
    v_cvt_pk_bf16_f32 v79, v30, v31
    v_lshlrev_b32 v16, 16, v80
    v_and_b32 v17, 0xffff0000, v80
    v_pk_fma_f32 v[16:17], v[16:17], v[12:13], v[14:15] op_sel_hi:[1,0,0]
    v_cvt_pk_bf16_f32 v80, v16, v17
    v_lshlrev_b32 v18, 16, v81
    v_and_b32 v19, 0xffff0000, v81
    v_pk_fma_f32 v[18:19], v[18:19], v[12:13], v[14:15] op_sel_hi:[1,0,0]
    v_cvt_pk_bf16_f32 v81, v18, v19
    v_lshlrev_b32 v20, 16, v82
    v_and_b32 v21, 0xffff0000, v82
    v_pk_fma_f32 v[20:21], v[20:21], v[12:13], v[14:15] op_sel_hi:[1,0,0]
    v_cvt_pk_bf16_f32 v82, v20, v21
    v_lshlrev_b32 v22, 16, v83
    v_and_b32 v23, 0xffff0000, v83
    v_pk_fma_f32 v[22:23], v[22:23], v[12:13], v[14:15] op_sel_hi:[1,0,0]
    v_cvt_pk_bf16_f32 v83, v22, v23
    v_lshlrev_b32 v24, 16, v84
    v_and_b32 v25, 0xffff0000, v84
    v_pk_fma_f32 v[24:25], v[24:25], v[12:13], v[14:15] op_sel_hi:[1,0,0]
    v_cvt_pk_bf16_f32 v84, v24, v25
    v_lshlrev_b32 v26, 16, v85
    v_and_b32 v27, 0xffff0000, v85
    v_pk_fma_f32 v[26:27], v[26:27], v[12:13], v[14:15] op_sel_hi:[1,0,0]
    v_cvt_pk_bf16_f32 v85, v26, v27
    v_lshlrev_b32 v28, 16, v86
    v_and_b32 v29, 0xffff0000, v86
    v_pk_fma_f32 v[28:29], v[28:29], v[12:13], v[14:15] op_sel_hi:[1,0,0]
    v_cvt_pk_bf16_f32 v86, v28, v29
    v_lshlrev_b32 v30, 16, v87
    v_and_b32 v31, 0xffff0000, v87
    v_pk_fma_f32 v[30:31], v[30:31], v[12:13], v[14:15] op_sel_hi:[1,0,0]
    v_cvt_pk_bf16_f32 v87, v30, v31
    v_lshlrev_b32 v16, 16, v88
    v_and_b32 v17, 0xffff0000, v88
    v_pk_fma_f32 v[16:17], v[16:17], v[12:13], v[14:15] op_sel_hi:[1,0,0]
    v_cvt_pk_bf16_f32 v88, v16, v17
    v_lshlrev_b32 v18, 16, v89
    v_and_b32 v19, 0xffff0000, v89
    v_pk_fma_f32 v[18:19], v[18:19], v[12:13], v[14:15] op_sel_hi:[1,0,0]
    v_cvt_pk_bf16_f32 v89, v18, v19
    v_lshlrev_b32 v20, 16, v90
    v_and_b32 v21, 0xffff0000, v90
    v_pk_fma_f32 v[20:21], v[20:21], v[12:13], v[14:15] op_sel_hi:[1,0,0]
    v_cvt_pk_bf16_f32 v90, v20, v21
    v_lshlrev_b32 v22, 16, v91
    v_and_b32 v23, 0xffff0000, v91
    v_pk_fma_f32 v[22:23], v[22:23], v[12:13], v[14:15] op_sel_hi:[1,0,0]
    v_cvt_pk_bf16_f32 v91, v22, v23
    v_lshlrev_b32 v24, 16, v92
    v_and_b32 v25, 0xffff0000, v92
    v_pk_fma_f32 v[24:25], v[24:25], v[12:13], v[14:15] op_sel_hi:[1,0,0]
    v_cvt_pk_bf16_f32 v92, v24, v25
    v_lshlrev_b32 v26, 16, v93
    v_and_b32 v27, 0xffff0000, v93
    v_pk_fma_f32 v[26:27], v[26:27], v[12:13], v[14:15] op_sel_hi:[1,0,0]
    v_cvt_pk_bf16_f32 v93, v26, v27
    v_lshlrev_b32 v28, 16, v94
    v_and_b32 v29, 0xffff0000, v94
    v_pk_fma_f32 v[28:29], v[28:29], v[12:13], v[14:15] op_sel_hi:[1,0,0]
    v_cvt_pk_bf16_f32 v94, v28, v29
    v_lshlrev_b32 v30, 16, v95
    v_and_b32 v31, 0xffff0000, v95
    v_pk_fma_f32 v[30:31], v[30:31], v[12:13], v[14:15] op_sel_hi:[1,0,0]
    v_cvt_pk_bf16_f32 v95, v30, v31
    buffer_store_dwordx4 v[64:67], v1, s[20:23], s34 offen offset:0
    buffer_store_dwordx4 v[68:71], v1, s[20:23], s34 offen offset:1024
    buffer_store_dwordx4 v[72:75], v1, s[20:23], s34 offen offset:2048
    buffer_store_dwordx4 v[76:79], v1, s[20:23], s34 offen offset:3072
    buffer_store_dwordx4 v[80:83], v1, s[20:23], s35 offen offset:0
    buffer_store_dwordx4 v[84:87], v1, s[20:23], s35 offen offset:1024
    buffer_store_dwordx4 v[88:91], v1, s[20:23], s35 offen offset:2048
    buffer_store_dwordx4 v[92:95], v1, s[20:23], s35 offen offset:3072
    v_mov_b32 v6, 0
    v_mov_b32 v7, 0
    v_mov_b32 v8, 0
    v_mov_b32 v9, 0
    s_waitcnt vmcnt(31)
    v_dot2c_f32_bf16 v6, v96, v4
    v_dot2c_f32_bf16 v7, v97, v4
    v_dot2c_f32_bf16 v8, v98, v4
    v_dot2c_f32_bf16 v9, v99, v4
    s_waitcnt vmcnt(30)
    v_dot2c_f32_bf16 v6, v100, v4
    v_dot2c_f32_bf16 v7, v101, v4
    v_dot2c_f32_bf16 v8, v102, v4
    v_dot2c_f32_bf16 v9, v103, v4
    s_waitcnt vmcnt(29)
    v_dot2c_f32_bf16 v6, v104, v4
    v_dot2c_f32_bf16 v7, v105, v4
    v_dot2c_f32_bf16 v8, v106, v4
    v_dot2c_f32_bf16 v9, v107, v4
    s_waitcnt vmcnt(28)
    v_dot2c_f32_bf16 v6, v108, v4
    v_dot2c_f32_bf16 v7, v109, v4
    v_dot2c_f32_bf16 v8, v110, v4
    v_dot2c_f32_bf16 v9, v111, v4
    s_waitcnt vmcnt(27)
    v_dot2c_f32_bf16 v6, v112, v4
    v_dot2c_f32_bf16 v7, v113, v4
    v_dot2c_f32_bf16 v8, v114, v4
    v_dot2c_f32_bf16 v9, v115, v4
    s_waitcnt vmcnt(26)
    v_dot2c_f32_bf16 v6, v116, v4
    v_dot2c_f32_bf16 v7, v117, v4
    v_dot2c_f32_bf16 v8, v118, v4
    v_dot2c_f32_bf16 v9, v119, v4
    s_waitcnt vmcnt(25)
    v_dot2c_f32_bf16 v6, v120, v4
    v_dot2c_f32_bf16 v7, v121, v4
    v_dot2c_f32_bf16 v8, v122, v4
    v_dot2c_f32_bf16 v9, v123, v4
    s_waitcnt vmcnt(24)
    v_dot2c_f32_bf16 v6, v124, v4
    v_dot2c_f32_bf16 v7, v125, v4
    v_dot2c_f32_bf16 v8, v126, v4
    v_dot2c_f32_bf16 v9, v127, v4
    s_nop 2
    v_add_f32 v6, v6, v7
    v_add_f32 v8, v8, v9
    v_add_f32 v6, v6, v8
    s_nop 1
    v_add_f32_dpp v6, v6, v6 row_shr:1 row_mask:0xf bank_mask:0xf bound_ctrl:0
    s_nop 1
    v_add_f32_dpp v6, v6, v6 row_shr:2 row_mask:0xf bank_mask:0xf bound_ctrl:0
    s_nop 1
    v_add_f32_dpp v6, v6, v6 row_shr:4 row_mask:0xf bank_mask:0xf bound_ctrl:0
    s_nop 1
    v_add_f32_dpp v6, v6, v6 row_shr:8 row_mask:0xf bank_mask:0xf bound_ctrl:0
    s_nop 1
    v_add_f32_dpp v6, v6, v6 row_bcast:15 row_mask:0xa bank_mask:0xf
    s_nop 1
    v_add_f32_dpp v6, v6, v6 row_bcast:31 row_mask:0xc bank_mask:0xf
    s_mov_b64 exec, s[28:29]
    ds_write_b32 v2, v6 offset:512
    s_waitcnt lgkmcnt(0)
    v_mov_b32 v7, s63
    ds_write_b32 v2, v7 offset:640
    s_mov_b64 exec, -1
    s_waitcnt lgkmcnt(0)
    s_barrier
    ds_read_b128 v[16:19], v3 offset:512
    ds_read_b128 v[20:23], v3 offset:528
    ds_read_b128 v[24:27], v3 offset:544
    ds_read_b128 v[28:31], v3 offset:560
    ds_read_b32 v7, v3 offset:640
    s_waitcnt lgkmcnt(0)
    v_readfirstlane_b32 s24, v7
    v_pk_add_f32 v[16:17], v[16:17], v[24:25]
    v_pk_add_f32 v[18:19], v[18:19], v[26:27]
    v_pk_add_f32 v[20:21], v[20:21], v[28:29]
    v_pk_add_f32 v[22:23], v[22:23], v[30:31]
    v_pk_add_f32 v[16:17], v[16:17], v[20:21]
    v_pk_add_f32 v[18:19], v[18:19], v[22:23]
    v_pk_add_f32 v[16:17], v[16:17], v[18:19]
    v_add_f32 v16, v16, v17
    s_add_u32 s25, s24, 1024
    s_cmp_lt_u32 s24, 224
    s_cselect_b32 s64, 1, 0
    s_cselect_b32 s25, s25, 1279
    s_cselect_b32 s94, 167772160, 0
    s_lshl_b32 s40, s25, 17
    s_add_u32 s41, s40, 4096
    s_sub_u32 s60, s25, 640
    s_mov_b32 s63, 0xffff
    buffer_load_dwordx4 v[64:67], v1, s[92:95], s40 offen offset:0 nt
    buffer_load_dwordx4 v[68:71], v1, s[92:95], s40 offen offset:1024 nt
    buffer_load_dwordx4 v[72:75], v1, s[92:95], s40 offen offset:2048 nt
    buffer_load_dwordx4 v[76:79], v1, s[92:95], s40 offen offset:3072 nt
    buffer_load_dwordx4 v[80:83], v1, s[92:95], s41 offen offset:0 nt
    buffer_load_dwordx4 v[84:87], v1, s[92:95], s41 offen offset:1024 nt
    buffer_load_dwordx4 v[88:91], v1, s[92:95], s41 offen offset:2048 nt
    buffer_load_dwordx4 v[92:95], v1, s[92:95], s41 offen offset:3072 nt
    s_lshl_b32 s15, s60, 1
    s_and_b32 s15, s15, 0xfffffffc
    s_load_dword s48, s[6:7], s15
    s_load_dword s54, s[8:9], s15
    v_mul_f32 v10, 0x37800000, v16
    v_cvt_pk_bf16_f32 v10, v10, v10
    v_and_b32 v10, 0xffff0000, v10
    v_xor_b32 v10, 0x80000000, v10
    v_mov_b32 v6, 0
    v_mov_b32 v7, 0
    v_mov_b32 v8, 0
    v_mov_b32 v9, 0
    v_lshlrev_b32 v16, 16, v96
    v_and_b32 v17, 0xffff0000, v96
    v_pk_add_f32 v[16:17], v[16:17], v[10:11] op_sel_hi:[1,0]
    v_pk_fma_f32 v[6:7], v[16:17], v[16:17], v[6:7]
    v_lshlrev_b32 v18, 16, v97
    v_and_b32 v19, 0xffff0000, v97
    v_pk_add_f32 v[18:19], v[18:19], v[10:11] op_sel_hi:[1,0]
    v_pk_fma_f32 v[8:9], v[18:19], v[18:19], v[8:9]
    v_lshlrev_b32 v20, 16, v98
    v_and_b32 v21, 0xffff0000, v98
    v_pk_add_f32 v[20:21], v[20:21], v[10:11] op_sel_hi:[1,0]
    v_pk_fma_f32 v[6:7], v[20:21], v[20:21], v[6:7]
    v_lshlrev_b32 v22, 16, v99
    v_and_b32 v23, 0xffff0000, v99
    v_pk_add_f32 v[22:23], v[22:23], v[10:11] op_sel_hi:[1,0]
    v_pk_fma_f32 v[8:9], v[22:23], v[22:23], v[8:9]
    v_lshlrev_b32 v24, 16, v100
    v_and_b32 v25, 0xffff0000, v100
    v_pk_add_f32 v[24:25], v[24:25], v[10:11] op_sel_hi:[1,0]
    v_pk_fma_f32 v[6:7], v[24:25], v[24:25], v[6:7]
    v_lshlrev_b32 v26, 16, v101
    v_and_b32 v27, 0xffff0000, v101
    v_pk_add_f32 v[26:27], v[26:27], v[10:11] op_sel_hi:[1,0]
    v_pk_fma_f32 v[8:9], v[26:27], v[26:27], v[8:9]
    v_lshlrev_b32 v28, 16, v102
    v_and_b32 v29, 0xffff0000, v102
    v_pk_add_f32 v[28:29], v[28:29], v[10:11] op_sel_hi:[1,0]
    v_pk_fma_f32 v[6:7], v[28:29], v[28:29], v[6:7]
    v_lshlrev_b32 v30, 16, v103
    v_and_b32 v31, 0xffff0000, v103
    v_pk_add_f32 v[30:31], v[30:31], v[10:11] op_sel_hi:[1,0]
    v_pk_fma_f32 v[8:9], v[30:31], v[30:31], v[8:9]
    v_lshlrev_b32 v16, 16, v104
    v_and_b32 v17, 0xffff0000, v104
    v_pk_add_f32 v[16:17], v[16:17], v[10:11] op_sel_hi:[1,0]
    v_pk_fma_f32 v[6:7], v[16:17], v[16:17], v[6:7]
    v_lshlrev_b32 v18, 16, v105
    v_and_b32 v19, 0xffff0000, v105
    v_pk_add_f32 v[18:19], v[18:19], v[10:11] op_sel_hi:[1,0]
    v_pk_fma_f32 v[8:9], v[18:19], v[18:19], v[8:9]
    v_lshlrev_b32 v20, 16, v106
    v_and_b32 v21, 0xffff0000, v106
    v_pk_add_f32 v[20:21], v[20:21], v[10:11] op_sel_hi:[1,0]
    v_pk_fma_f32 v[6:7], v[20:21], v[20:21], v[6:7]
    v_lshlrev_b32 v22, 16, v107
    v_and_b32 v23, 0xffff0000, v107
    v_pk_add_f32 v[22:23], v[22:23], v[10:11] op_sel_hi:[1,0]
    v_pk_fma_f32 v[8:9], v[22:23], v[22:23], v[8:9]
    v_lshlrev_b32 v24, 16, v108
    v_and_b32 v25, 0xffff0000, v108
    v_pk_add_f32 v[24:25], v[24:25], v[10:11] op_sel_hi:[1,0]
    v_pk_fma_f32 v[6:7], v[24:25], v[24:25], v[6:7]
    v_lshlrev_b32 v26, 16, v109
    v_and_b32 v27, 0xffff0000, v109
    v_pk_add_f32 v[26:27], v[26:27], v[10:11] op_sel_hi:[1,0]
    v_pk_fma_f32 v[8:9], v[26:27], v[26:27], v[8:9]
    v_lshlrev_b32 v28, 16, v110
    v_and_b32 v29, 0xffff0000, v110
    v_pk_add_f32 v[28:29], v[28:29], v[10:11] op_sel_hi:[1,0]
    v_pk_fma_f32 v[6:7], v[28:29], v[28:29], v[6:7]
    v_lshlrev_b32 v30, 16, v111
    v_and_b32 v31, 0xffff0000, v111
    v_pk_add_f32 v[30:31], v[30:31], v[10:11] op_sel_hi:[1,0]
    v_pk_fma_f32 v[8:9], v[30:31], v[30:31], v[8:9]
    v_lshlrev_b32 v16, 16, v112
    v_and_b32 v17, 0xffff0000, v112
    v_pk_add_f32 v[16:17], v[16:17], v[10:11] op_sel_hi:[1,0]
    v_pk_fma_f32 v[6:7], v[16:17], v[16:17], v[6:7]
    v_lshlrev_b32 v18, 16, v113
    v_and_b32 v19, 0xffff0000, v113
    v_pk_add_f32 v[18:19], v[18:19], v[10:11] op_sel_hi:[1,0]
    v_pk_fma_f32 v[8:9], v[18:19], v[18:19], v[8:9]
    v_lshlrev_b32 v20, 16, v114
    v_and_b32 v21, 0xffff0000, v114
    v_pk_add_f32 v[20:21], v[20:21], v[10:11] op_sel_hi:[1,0]
    v_pk_fma_f32 v[6:7], v[20:21], v[20:21], v[6:7]
    v_lshlrev_b32 v22, 16, v115
    v_and_b32 v23, 0xffff0000, v115
    v_pk_add_f32 v[22:23], v[22:23], v[10:11] op_sel_hi:[1,0]
    v_pk_fma_f32 v[8:9], v[22:23], v[22:23], v[8:9]
    v_lshlrev_b32 v24, 16, v116
    v_and_b32 v25, 0xffff0000, v116
    v_pk_add_f32 v[24:25], v[24:25], v[10:11] op_sel_hi:[1,0]
    v_pk_fma_f32 v[6:7], v[24:25], v[24:25], v[6:7]
    v_lshlrev_b32 v26, 16, v117
    v_and_b32 v27, 0xffff0000, v117
    v_pk_add_f32 v[26:27], v[26:27], v[10:11] op_sel_hi:[1,0]
    v_pk_fma_f32 v[8:9], v[26:27], v[26:27], v[8:9]
    v_lshlrev_b32 v28, 16, v118
    v_and_b32 v29, 0xffff0000, v118
    v_pk_add_f32 v[28:29], v[28:29], v[10:11] op_sel_hi:[1,0]
    v_pk_fma_f32 v[6:7], v[28:29], v[28:29], v[6:7]
    v_lshlrev_b32 v30, 16, v119
    v_and_b32 v31, 0xffff0000, v119
    v_pk_add_f32 v[30:31], v[30:31], v[10:11] op_sel_hi:[1,0]
    v_pk_fma_f32 v[8:9], v[30:31], v[30:31], v[8:9]
    v_lshlrev_b32 v16, 16, v120
    v_and_b32 v17, 0xffff0000, v120
    v_pk_add_f32 v[16:17], v[16:17], v[10:11] op_sel_hi:[1,0]
    v_pk_fma_f32 v[6:7], v[16:17], v[16:17], v[6:7]
    v_lshlrev_b32 v18, 16, v121
    v_and_b32 v19, 0xffff0000, v121
    v_pk_add_f32 v[18:19], v[18:19], v[10:11] op_sel_hi:[1,0]
    v_pk_fma_f32 v[8:9], v[18:19], v[18:19], v[8:9]
    v_lshlrev_b32 v20, 16, v122
    v_and_b32 v21, 0xffff0000, v122
    v_pk_add_f32 v[20:21], v[20:21], v[10:11] op_sel_hi:[1,0]
    v_pk_fma_f32 v[6:7], v[20:21], v[20:21], v[6:7]
    v_lshlrev_b32 v22, 16, v123
    v_and_b32 v23, 0xffff0000, v123
    v_pk_add_f32 v[22:23], v[22:23], v[10:11] op_sel_hi:[1,0]
    v_pk_fma_f32 v[8:9], v[22:23], v[22:23], v[8:9]
    v_lshlrev_b32 v24, 16, v124
    v_and_b32 v25, 0xffff0000, v124
    v_pk_add_f32 v[24:25], v[24:25], v[10:11] op_sel_hi:[1,0]
    v_pk_fma_f32 v[6:7], v[24:25], v[24:25], v[6:7]
    v_lshlrev_b32 v26, 16, v125
    v_and_b32 v27, 0xffff0000, v125
    v_pk_add_f32 v[26:27], v[26:27], v[10:11] op_sel_hi:[1,0]
    v_pk_fma_f32 v[8:9], v[26:27], v[26:27], v[8:9]
    v_lshlrev_b32 v28, 16, v126
    v_and_b32 v29, 0xffff0000, v126
    v_pk_add_f32 v[28:29], v[28:29], v[10:11] op_sel_hi:[1,0]
    v_pk_fma_f32 v[6:7], v[28:29], v[28:29], v[6:7]
    v_lshlrev_b32 v30, 16, v127
    v_and_b32 v31, 0xffff0000, v127
    v_pk_add_f32 v[30:31], v[30:31], v[10:11] op_sel_hi:[1,0]
    v_pk_fma_f32 v[8:9], v[30:31], v[30:31], v[8:9]
    v_pk_add_f32 v[6:7], v[6:7], v[8:9]
    v_add_f32 v6, v6, v7
    s_nop 1
    v_add_f32_dpp v6, v6, v6 row_shr:1 row_mask:0xf bank_mask:0xf bound_ctrl:0
    s_nop 1
    v_add_f32_dpp v6, v6, v6 row_shr:2 row_mask:0xf bank_mask:0xf bound_ctrl:0
    s_nop 1
    v_add_f32_dpp v6, v6, v6 row_shr:4 row_mask:0xf bank_mask:0xf bound_ctrl:0
    s_nop 1
    v_add_f32_dpp v6, v6, v6 row_shr:8 row_mask:0xf bank_mask:0xf bound_ctrl:0
    s_nop 1
    v_add_f32_dpp v6, v6, v6 row_bcast:15 row_mask:0xa bank_mask:0xf
    s_nop 1
    v_add_f32_dpp v6, v6, v6 row_bcast:31 row_mask:0xc bank_mask:0xf
    s_mov_b64 exec, s[28:29]
    ds_write_b32 v2, v6 offset:576
    s_mov_b64 exec, -1
    s_waitcnt lgkmcnt(0)
    s_barrier
    ds_read_b128 v[16:19], v3 offset:576
    ds_read_b128 v[20:23], v3 offset:592
    ds_read_b128 v[24:27], v3 offset:608
    ds_read_b128 v[28:31], v3 offset:624
    s_waitcnt lgkmcnt(0)
    v_pk_add_f32 v[16:17], v[16:17], v[24:25]
    v_pk_add_f32 v[18:19], v[18:19], v[26:27]
    v_pk_add_f32 v[20:21], v[20:21], v[28:29]
    v_pk_add_f32 v[22:23], v[22:23], v[30:31]
    v_pk_add_f32 v[16:17], v[16:17], v[20:21]
    v_pk_add_f32 v[18:19], v[18:19], v[22:23]
    v_pk_add_f32 v[16:17], v[16:17], v[18:19]
    v_add_f32 v16, v16, v17
    s_cmp_lg_u32 s62, 0
    s_cbranch_scc1 L_notk2
    s_cmp_eq_u32 s64, 0
    s_cbranch_scc1 L_notk2
    s_mov_b32 s63, 1
    s_atomic_add s63, s[12:13], 64 glc
L_notk2:
    s_and_b32 s30, s58, 1
    s_lshl_b32 s31, s46, 16
    s_and_b32 s24, s46, s27
    s_cmp_eq_u32 s30, 1
    s_cselect_b32 s24, s24, s31
    s_lshl_b32 s31, s52, 16
    s_and_b32 s25, s52, s27
    s_cmp_eq_u32 s30, 1
    s_cselect_b32 s25, s25, s31
    v_mul_f32 v17, 0x37800000, v16
    v_cvt_pk_bf16_f32 v17, v17, v17
    v_and_b32 v17, 0xffff0000, v17
    v_add_f32 v17, 0x3727c5ac, v17
    v_cvt_pk_bf16_f32 v17, v17, v17
    v_and_b32 v17, 0xffff0000, v17
    v_sqrt_f32 v17, v17
    s_nop 0
    v_cvt_pk_bf16_f32 v17, v17, v17
    v_and_b32 v17, 0xffff0000, v17
    v_rcp_f32 v12, v17
    s_nop 0
    v_fma_f32 v18, -v17, v12, 1.0
    v_fma_f32 v12, v18, v12, v12
    v_mul_f32 v12, s24, v12
    v_mov_b32 v14, s25
    v_fma_f32 v14, v10, v12, v14
    v_lshlrev_b32 v16, 16, v96
    v_and_b32 v17, 0xffff0000, v96
    v_pk_fma_f32 v[16:17], v[16:17], v[12:13], v[14:15] op_sel_hi:[1,0,0]
    v_cvt_pk_bf16_f32 v96, v16, v17
    v_lshlrev_b32 v18, 16, v97
    v_and_b32 v19, 0xffff0000, v97
    v_pk_fma_f32 v[18:19], v[18:19], v[12:13], v[14:15] op_sel_hi:[1,0,0]
    v_cvt_pk_bf16_f32 v97, v18, v19
    v_lshlrev_b32 v20, 16, v98
    v_and_b32 v21, 0xffff0000, v98
    v_pk_fma_f32 v[20:21], v[20:21], v[12:13], v[14:15] op_sel_hi:[1,0,0]
    v_cvt_pk_bf16_f32 v98, v20, v21
    v_lshlrev_b32 v22, 16, v99
    v_and_b32 v23, 0xffff0000, v99
    v_pk_fma_f32 v[22:23], v[22:23], v[12:13], v[14:15] op_sel_hi:[1,0,0]
    v_cvt_pk_bf16_f32 v99, v22, v23
    v_lshlrev_b32 v24, 16, v100
    v_and_b32 v25, 0xffff0000, v100
    v_pk_fma_f32 v[24:25], v[24:25], v[12:13], v[14:15] op_sel_hi:[1,0,0]
    v_cvt_pk_bf16_f32 v100, v24, v25
    v_lshlrev_b32 v26, 16, v101
    v_and_b32 v27, 0xffff0000, v101
    v_pk_fma_f32 v[26:27], v[26:27], v[12:13], v[14:15] op_sel_hi:[1,0,0]
    v_cvt_pk_bf16_f32 v101, v26, v27
    v_lshlrev_b32 v28, 16, v102
    v_and_b32 v29, 0xffff0000, v102
    v_pk_fma_f32 v[28:29], v[28:29], v[12:13], v[14:15] op_sel_hi:[1,0,0]
    v_cvt_pk_bf16_f32 v102, v28, v29
    v_lshlrev_b32 v30, 16, v103
    v_and_b32 v31, 0xffff0000, v103
    v_pk_fma_f32 v[30:31], v[30:31], v[12:13], v[14:15] op_sel_hi:[1,0,0]
    v_cvt_pk_bf16_f32 v103, v30, v31
    v_lshlrev_b32 v16, 16, v104
    v_and_b32 v17, 0xffff0000, v104
    v_pk_fma_f32 v[16:17], v[16:17], v[12:13], v[14:15] op_sel_hi:[1,0,0]
    v_cvt_pk_bf16_f32 v104, v16, v17
    v_lshlrev_b32 v18, 16, v105
    v_and_b32 v19, 0xffff0000, v105
    v_pk_fma_f32 v[18:19], v[18:19], v[12:13], v[14:15] op_sel_hi:[1,0,0]
    v_cvt_pk_bf16_f32 v105, v18, v19
    v_lshlrev_b32 v20, 16, v106
    v_and_b32 v21, 0xffff0000, v106
    v_pk_fma_f32 v[20:21], v[20:21], v[12:13], v[14:15] op_sel_hi:[1,0,0]
    v_cvt_pk_bf16_f32 v106, v20, v21
    v_lshlrev_b32 v22, 16, v107
    v_and_b32 v23, 0xffff0000, v107
    v_pk_fma_f32 v[22:23], v[22:23], v[12:13], v[14:15] op_sel_hi:[1,0,0]
    v_cvt_pk_bf16_f32 v107, v22, v23
    v_lshlrev_b32 v24, 16, v108
    v_and_b32 v25, 0xffff0000, v108
    v_pk_fma_f32 v[24:25], v[24:25], v[12:13], v[14:15] op_sel_hi:[1,0,0]
    v_cvt_pk_bf16_f32 v108, v24, v25
    v_lshlrev_b32 v26, 16, v109
    v_and_b32 v27, 0xffff0000, v109
    v_pk_fma_f32 v[26:27], v[26:27], v[12:13], v[14:15] op_sel_hi:[1,0,0]
    v_cvt_pk_bf16_f32 v109, v26, v27
    v_lshlrev_b32 v28, 16, v110
    v_and_b32 v29, 0xffff0000, v110
    v_pk_fma_f32 v[28:29], v[28:29], v[12:13], v[14:15] op_sel_hi:[1,0,0]
    v_cvt_pk_bf16_f32 v110, v28, v29
    v_lshlrev_b32 v30, 16, v111
    v_and_b32 v31, 0xffff0000, v111
    v_pk_fma_f32 v[30:31], v[30:31], v[12:13], v[14:15] op_sel_hi:[1,0,0]
    v_cvt_pk_bf16_f32 v111, v30, v31
    v_lshlrev_b32 v16, 16, v112
    v_and_b32 v17, 0xffff0000, v112
    v_pk_fma_f32 v[16:17], v[16:17], v[12:13], v[14:15] op_sel_hi:[1,0,0]
    v_cvt_pk_bf16_f32 v112, v16, v17
    v_lshlrev_b32 v18, 16, v113
    v_and_b32 v19, 0xffff0000, v113
    v_pk_fma_f32 v[18:19], v[18:19], v[12:13], v[14:15] op_sel_hi:[1,0,0]
    v_cvt_pk_bf16_f32 v113, v18, v19
    v_lshlrev_b32 v20, 16, v114
    v_and_b32 v21, 0xffff0000, v114
    v_pk_fma_f32 v[20:21], v[20:21], v[12:13], v[14:15] op_sel_hi:[1,0,0]
    v_cvt_pk_bf16_f32 v114, v20, v21
    v_lshlrev_b32 v22, 16, v115
    v_and_b32 v23, 0xffff0000, v115
    v_pk_fma_f32 v[22:23], v[22:23], v[12:13], v[14:15] op_sel_hi:[1,0,0]
    v_cvt_pk_bf16_f32 v115, v22, v23
    v_lshlrev_b32 v24, 16, v116
    v_and_b32 v25, 0xffff0000, v116
    v_pk_fma_f32 v[24:25], v[24:25], v[12:13], v[14:15] op_sel_hi:[1,0,0]
    v_cvt_pk_bf16_f32 v116, v24, v25
    v_lshlrev_b32 v26, 16, v117
    v_and_b32 v27, 0xffff0000, v117
    v_pk_fma_f32 v[26:27], v[26:27], v[12:13], v[14:15] op_sel_hi:[1,0,0]
    v_cvt_pk_bf16_f32 v117, v26, v27
    v_lshlrev_b32 v28, 16, v118
    v_and_b32 v29, 0xffff0000, v118
    v_pk_fma_f32 v[28:29], v[28:29], v[12:13], v[14:15] op_sel_hi:[1,0,0]
    v_cvt_pk_bf16_f32 v118, v28, v29
    v_lshlrev_b32 v30, 16, v119
    v_and_b32 v31, 0xffff0000, v119
    v_pk_fma_f32 v[30:31], v[30:31], v[12:13], v[14:15] op_sel_hi:[1,0,0]
    v_cvt_pk_bf16_f32 v119, v30, v31
    v_lshlrev_b32 v16, 16, v120
    v_and_b32 v17, 0xffff0000, v120
    v_pk_fma_f32 v[16:17], v[16:17], v[12:13], v[14:15] op_sel_hi:[1,0,0]
    v_cvt_pk_bf16_f32 v120, v16, v17
    v_lshlrev_b32 v18, 16, v121
    v_and_b32 v19, 0xffff0000, v121
    v_pk_fma_f32 v[18:19], v[18:19], v[12:13], v[14:15] op_sel_hi:[1,0,0]
    v_cvt_pk_bf16_f32 v121, v18, v19
    v_lshlrev_b32 v20, 16, v122
    v_and_b32 v21, 0xffff0000, v122
    v_pk_fma_f32 v[20:21], v[20:21], v[12:13], v[14:15] op_sel_hi:[1,0,0]
    v_cvt_pk_bf16_f32 v122, v20, v21
    v_lshlrev_b32 v22, 16, v123
    v_and_b32 v23, 0xffff0000, v123
    v_pk_fma_f32 v[22:23], v[22:23], v[12:13], v[14:15] op_sel_hi:[1,0,0]
    v_cvt_pk_bf16_f32 v123, v22, v23
    v_lshlrev_b32 v24, 16, v124
    v_and_b32 v25, 0xffff0000, v124
    v_pk_fma_f32 v[24:25], v[24:25], v[12:13], v[14:15] op_sel_hi:[1,0,0]
    v_cvt_pk_bf16_f32 v124, v24, v25
    v_lshlrev_b32 v26, 16, v125
    v_and_b32 v27, 0xffff0000, v125
    v_pk_fma_f32 v[26:27], v[26:27], v[12:13], v[14:15] op_sel_hi:[1,0,0]
    v_cvt_pk_bf16_f32 v125, v26, v27
    v_lshlrev_b32 v28, 16, v126
    v_and_b32 v29, 0xffff0000, v126
    v_pk_fma_f32 v[28:29], v[28:29], v[12:13], v[14:15] op_sel_hi:[1,0,0]
    v_cvt_pk_bf16_f32 v126, v28, v29
    v_lshlrev_b32 v30, 16, v127
    v_and_b32 v31, 0xffff0000, v127
    v_pk_fma_f32 v[30:31], v[30:31], v[12:13], v[14:15] op_sel_hi:[1,0,0]
    v_cvt_pk_bf16_f32 v127, v30, v31
    buffer_store_dwordx4 v[96:99], v1, s[20:23], s36 offen offset:0
    buffer_store_dwordx4 v[100:103], v1, s[20:23], s36 offen offset:1024
    buffer_store_dwordx4 v[104:107], v1, s[20:23], s36 offen offset:2048
    buffer_store_dwordx4 v[108:111], v1, s[20:23], s36 offen offset:3072
    buffer_store_dwordx4 v[112:115], v1, s[20:23], s37 offen offset:0
    buffer_store_dwordx4 v[116:119], v1, s[20:23], s37 offen offset:1024
    buffer_store_dwordx4 v[120:123], v1, s[20:23], s37 offen offset:2048
    buffer_store_dwordx4 v[124:127], v1, s[20:23], s37 offen offset:3072
    v_mov_b32 v6, 0
    v_mov_b32 v7, 0
    v_mov_b32 v8, 0
    v_mov_b32 v9, 0
    s_waitcnt vmcnt(31)
    v_dot2c_f32_bf16 v6, v32, v4
    v_dot2c_f32_bf16 v7, v33, v4
    v_dot2c_f32_bf16 v8, v34, v4
    v_dot2c_f32_bf16 v9, v35, v4
    s_waitcnt vmcnt(30)
    v_dot2c_f32_bf16 v6, v36, v4
    v_dot2c_f32_bf16 v7, v37, v4
    v_dot2c_f32_bf16 v8, v38, v4
    v_dot2c_f32_bf16 v9, v39, v4
    s_waitcnt vmcnt(29)
    v_dot2c_f32_bf16 v6, v40, v4
    v_dot2c_f32_bf16 v7, v41, v4
    v_dot2c_f32_bf16 v8, v42, v4
    v_dot2c_f32_bf16 v9, v43, v4
    s_waitcnt vmcnt(28)
    v_dot2c_f32_bf16 v6, v44, v4
    v_dot2c_f32_bf16 v7, v45, v4
    v_dot2c_f32_bf16 v8, v46, v4
    v_dot2c_f32_bf16 v9, v47, v4
    s_waitcnt vmcnt(27)
    v_dot2c_f32_bf16 v6, v48, v4
    v_dot2c_f32_bf16 v7, v49, v4
    v_dot2c_f32_bf16 v8, v50, v4
    v_dot2c_f32_bf16 v9, v51, v4
    s_waitcnt vmcnt(26)
    v_dot2c_f32_bf16 v6, v52, v4
    v_dot2c_f32_bf16 v7, v53, v4
    v_dot2c_f32_bf16 v8, v54, v4
    v_dot2c_f32_bf16 v9, v55, v4
    s_waitcnt vmcnt(25)
    v_dot2c_f32_bf16 v6, v56, v4
    v_dot2c_f32_bf16 v7, v57, v4
    v_dot2c_f32_bf16 v8, v58, v4
    v_dot2c_f32_bf16 v9, v59, v4
    s_waitcnt vmcnt(24)
    v_dot2c_f32_bf16 v6, v60, v4
    v_dot2c_f32_bf16 v7, v61, v4
    v_dot2c_f32_bf16 v8, v62, v4
    v_dot2c_f32_bf16 v9, v63, v4
    s_nop 2
    v_add_f32 v6, v6, v7
    v_add_f32 v8, v8, v9
    v_add_f32 v6, v6, v8
    s_nop 1
    v_add_f32_dpp v6, v6, v6 row_shr:1 row_mask:0xf bank_mask:0xf bound_ctrl:0
    s_nop 1
    v_add_f32_dpp v6, v6, v6 row_shr:2 row_mask:0xf bank_mask:0xf bound_ctrl:0
    s_nop 1
    v_add_f32_dpp v6, v6, v6 row_shr:4 row_mask:0xf bank_mask:0xf bound_ctrl:0
    s_nop 1
    v_add_f32_dpp v6, v6, v6 row_shr:8 row_mask:0xf bank_mask:0xf bound_ctrl:0
    s_nop 1
    v_add_f32_dpp v6, v6, v6 row_bcast:15 row_mask:0xa bank_mask:0xf
    s_nop 1
    v_add_f32_dpp v6, v6, v6 row_bcast:31 row_mask:0xc bank_mask:0xf
    s_mov_b64 exec, s[28:29]
    ds_write_b32 v2, v6 offset:768
    s_waitcnt lgkmcnt(0)
    v_mov_b32 v7, s63
    ds_write_b32 v2, v7 offset:896
    s_mov_b64 exec, -1
    s_waitcnt lgkmcnt(0)
    s_barrier
    ds_read_b128 v[16:19], v3 offset:768
    ds_read_b128 v[20:23], v3 offset:784
    ds_read_b128 v[24:27], v3 offset:800
    ds_read_b128 v[28:31], v3 offset:816
    ds_read_b32 v7, v3 offset:896
    s_waitcnt lgkmcnt(0)
    v_readfirstlane_b32 s24, v7
    v_pk_add_f32 v[16:17], v[16:17], v[24:25]
    v_pk_add_f32 v[18:19], v[18:19], v[26:27]
    v_pk_add_f32 v[20:21], v[20:21], v[28:29]
    v_pk_add_f32 v[22:23], v[22:23], v[30:31]
    v_pk_add_f32 v[16:17], v[16:17], v[20:21]
    v_pk_add_f32 v[18:19], v[18:19], v[22:23]
    v_pk_add_f32 v[16:17], v[16:17], v[18:19]
    v_add_f32 v16, v16, v17
    s_add_u32 s25, s24, 1248
    s_cmp_lt_u32 s24, 32
    s_cselect_b32 s65, 1, 0
    s_cselect_b32 s25, s25, 1279
    s_cselect_b32 s94, 167772160, 0
    s_lshl_b32 s42, s25, 17
    s_add_u32 s43, s42, 4096
    s_sub_u32 s61, s25, 640
    s_mov_b32 s63, 0xffff
    buffer_load_dwordx4 v[96:99], v1, s[92:95], s42 offen offset:0 nt
    buffer_load_dwordx4 v[100:103], v1, s[92:95], s42 offen offset:1024 nt
    buffer_load_dwordx4 v[104:107], v1, s[92:95], s42 offen offset:2048 nt
    buffer_load_dwordx4 v[108:111], v1, s[92:95], s42 offen offset:3072 nt
    buffer_load_dwordx4 v[112:115], v1, s[92:95], s43 offen offset:0 nt
    buffer_load_dwordx4 v[116:119], v1, s[92:95], s43 offen offset:1024 nt
    buffer_load_dwordx4 v[120:123], v1, s[92:95], s43 offen offset:2048 nt
    buffer_load_dwordx4 v[124:127], v1, s[92:95], s43 offen offset:3072 nt
    s_lshl_b32 s15, s61, 1
    s_and_b32 s15, s15, 0xfffffffc
    s_load_dword s49, s[6:7], s15
    s_load_dword s55, s[8:9], s15
    s_cmp_lg_u32 s62, 0
    s_cbranch_scc1 L_nodone
    s_mov_b32 s63, 1
    s_atomic_add s63, s[12:13], 128 glc
L_nodone:
    v_mul_f32 v10, 0x37800000, v16
    v_cvt_pk_bf16_f32 v10, v10, v10
    v_and_b32 v10, 0xffff0000, v10
    v_xor_b32 v10, 0x80000000, v10
    v_mov_b32 v6, 0
    v_mov_b32 v7, 0
    v_mov_b32 v8, 0
    v_mov_b32 v9, 0
    v_lshlrev_b32 v16, 16, v32
    v_and_b32 v17, 0xffff0000, v32
    v_pk_add_f32 v[16:17], v[16:17], v[10:11] op_sel_hi:[1,0]
    v_pk_fma_f32 v[6:7], v[16:17], v[16:17], v[6:7]
    v_lshlrev_b32 v18, 16, v33
    v_and_b32 v19, 0xffff0000, v33
    v_pk_add_f32 v[18:19], v[18:19], v[10:11] op_sel_hi:[1,0]
    v_pk_fma_f32 v[8:9], v[18:19], v[18:19], v[8:9]
    v_lshlrev_b32 v20, 16, v34
    v_and_b32 v21, 0xffff0000, v34
    v_pk_add_f32 v[20:21], v[20:21], v[10:11] op_sel_hi:[1,0]
    v_pk_fma_f32 v[6:7], v[20:21], v[20:21], v[6:7]
    v_lshlrev_b32 v22, 16, v35
    v_and_b32 v23, 0xffff0000, v35
    v_pk_add_f32 v[22:23], v[22:23], v[10:11] op_sel_hi:[1,0]
    v_pk_fma_f32 v[8:9], v[22:23], v[22:23], v[8:9]
    v_lshlrev_b32 v24, 16, v36
    v_and_b32 v25, 0xffff0000, v36
    v_pk_add_f32 v[24:25], v[24:25], v[10:11] op_sel_hi:[1,0]
    v_pk_fma_f32 v[6:7], v[24:25], v[24:25], v[6:7]
    v_lshlrev_b32 v26, 16, v37
    v_and_b32 v27, 0xffff0000, v37
    v_pk_add_f32 v[26:27], v[26:27], v[10:11] op_sel_hi:[1,0]
    v_pk_fma_f32 v[8:9], v[26:27], v[26:27], v[8:9]
    v_lshlrev_b32 v28, 16, v38
    v_and_b32 v29, 0xffff0000, v38
    v_pk_add_f32 v[28:29], v[28:29], v[10:11] op_sel_hi:[1,0]
    v_pk_fma_f32 v[6:7], v[28:29], v[28:29], v[6:7]
    v_lshlrev_b32 v30, 16, v39
    v_and_b32 v31, 0xffff0000, v39
    v_pk_add_f32 v[30:31], v[30:31], v[10:11] op_sel_hi:[1,0]
    v_pk_fma_f32 v[8:9], v[30:31], v[30:31], v[8:9]
    v_lshlrev_b32 v16, 16, v40
    v_and_b32 v17, 0xffff0000, v40
    v_pk_add_f32 v[16:17], v[16:17], v[10:11] op_sel_hi:[1,0]
    v_pk_fma_f32 v[6:7], v[16:17], v[16:17], v[6:7]
    v_lshlrev_b32 v18, 16, v41
    v_and_b32 v19, 0xffff0000, v41
    v_pk_add_f32 v[18:19], v[18:19], v[10:11] op_sel_hi:[1,0]
    v_pk_fma_f32 v[8:9], v[18:19], v[18:19], v[8:9]
    v_lshlrev_b32 v20, 16, v42
    v_and_b32 v21, 0xffff0000, v42
    v_pk_add_f32 v[20:21], v[20:21], v[10:11] op_sel_hi:[1,0]
    v_pk_fma_f32 v[6:7], v[20:21], v[20:21], v[6:7]
    v_lshlrev_b32 v22, 16, v43
    v_and_b32 v23, 0xffff0000, v43
    v_pk_add_f32 v[22:23], v[22:23], v[10:11] op_sel_hi:[1,0]
    v_pk_fma_f32 v[8:9], v[22:23], v[22:23], v[8:9]
    v_lshlrev_b32 v24, 16, v44
    v_and_b32 v25, 0xffff0000, v44
    v_pk_add_f32 v[24:25], v[24:25], v[10:11] op_sel_hi:[1,0]
    v_pk_fma_f32 v[6:7], v[24:25], v[24:25], v[6:7]
    v_lshlrev_b32 v26, 16, v45
    v_and_b32 v27, 0xffff0000, v45
    v_pk_add_f32 v[26:27], v[26:27], v[10:11] op_sel_hi:[1,0]
    v_pk_fma_f32 v[8:9], v[26:27], v[26:27], v[8:9]
    v_lshlrev_b32 v28, 16, v46
    v_and_b32 v29, 0xffff0000, v46
    v_pk_add_f32 v[28:29], v[28:29], v[10:11] op_sel_hi:[1,0]
    v_pk_fma_f32 v[6:7], v[28:29], v[28:29], v[6:7]
    v_lshlrev_b32 v30, 16, v47
    v_and_b32 v31, 0xffff0000, v47
    v_pk_add_f32 v[30:31], v[30:31], v[10:11] op_sel_hi:[1,0]
    v_pk_fma_f32 v[8:9], v[30:31], v[30:31], v[8:9]
    v_lshlrev_b32 v16, 16, v48
    v_and_b32 v17, 0xffff0000, v48
    v_pk_add_f32 v[16:17], v[16:17], v[10:11] op_sel_hi:[1,0]
    v_pk_fma_f32 v[6:7], v[16:17], v[16:17], v[6:7]
    v_lshlrev_b32 v18, 16, v49
    v_and_b32 v19, 0xffff0000, v49
    v_pk_add_f32 v[18:19], v[18:19], v[10:11] op_sel_hi:[1,0]
    v_pk_fma_f32 v[8:9], v[18:19], v[18:19], v[8:9]
    v_lshlrev_b32 v20, 16, v50
    v_and_b32 v21, 0xffff0000, v50
    v_pk_add_f32 v[20:21], v[20:21], v[10:11] op_sel_hi:[1,0]
    v_pk_fma_f32 v[6:7], v[20:21], v[20:21], v[6:7]
    v_lshlrev_b32 v22, 16, v51
    v_and_b32 v23, 0xffff0000, v51
    v_pk_add_f32 v[22:23], v[22:23], v[10:11] op_sel_hi:[1,0]
    v_pk_fma_f32 v[8:9], v[22:23], v[22:23], v[8:9]
    v_lshlrev_b32 v24, 16, v52
    v_and_b32 v25, 0xffff0000, v52
    v_pk_add_f32 v[24:25], v[24:25], v[10:11] op_sel_hi:[1,0]
    v_pk_fma_f32 v[6:7], v[24:25], v[24:25], v[6:7]
    v_lshlrev_b32 v26, 16, v53
    v_and_b32 v27, 0xffff0000, v53
    v_pk_add_f32 v[26:27], v[26:27], v[10:11] op_sel_hi:[1,0]
    v_pk_fma_f32 v[8:9], v[26:27], v[26:27], v[8:9]
    v_lshlrev_b32 v28, 16, v54
    v_and_b32 v29, 0xffff0000, v54
    v_pk_add_f32 v[28:29], v[28:29], v[10:11] op_sel_hi:[1,0]
    v_pk_fma_f32 v[6:7], v[28:29], v[28:29], v[6:7]
    v_lshlrev_b32 v30, 16, v55
    v_and_b32 v31, 0xffff0000, v55
    v_pk_add_f32 v[30:31], v[30:31], v[10:11] op_sel_hi:[1,0]
    v_pk_fma_f32 v[8:9], v[30:31], v[30:31], v[8:9]
    v_lshlrev_b32 v16, 16, v56
    v_and_b32 v17, 0xffff0000, v56
    v_pk_add_f32 v[16:17], v[16:17], v[10:11] op_sel_hi:[1,0]
    v_pk_fma_f32 v[6:7], v[16:17], v[16:17], v[6:7]
    v_lshlrev_b32 v18, 16, v57
    v_and_b32 v19, 0xffff0000, v57
    v_pk_add_f32 v[18:19], v[18:19], v[10:11] op_sel_hi:[1,0]
    v_pk_fma_f32 v[8:9], v[18:19], v[18:19], v[8:9]
    v_lshlrev_b32 v20, 16, v58
    v_and_b32 v21, 0xffff0000, v58
    v_pk_add_f32 v[20:21], v[20:21], v[10:11] op_sel_hi:[1,0]
    v_pk_fma_f32 v[6:7], v[20:21], v[20:21], v[6:7]
    v_lshlrev_b32 v22, 16, v59
    v_and_b32 v23, 0xffff0000, v59
    v_pk_add_f32 v[22:23], v[22:23], v[10:11] op_sel_hi:[1,0]
    v_pk_fma_f32 v[8:9], v[22:23], v[22:23], v[8:9]
    v_lshlrev_b32 v24, 16, v60
    v_and_b32 v25, 0xffff0000, v60
    v_pk_add_f32 v[24:25], v[24:25], v[10:11] op_sel_hi:[1,0]
    v_pk_fma_f32 v[6:7], v[24:25], v[24:25], v[6:7]
    v_lshlrev_b32 v26, 16, v61
    v_and_b32 v27, 0xffff0000, v61
    v_pk_add_f32 v[26:27], v[26:27], v[10:11] op_sel_hi:[1,0]
    v_pk_fma_f32 v[8:9], v[26:27], v[26:27], v[8:9]
    v_lshlrev_b32 v28, 16, v62
    v_and_b32 v29, 0xffff0000, v62
    v_pk_add_f32 v[28:29], v[28:29], v[10:11] op_sel_hi:[1,0]
    v_pk_fma_f32 v[6:7], v[28:29], v[28:29], v[6:7]
    v_lshlrev_b32 v30, 16, v63
    v_and_b32 v31, 0xffff0000, v63
    v_pk_add_f32 v[30:31], v[30:31], v[10:11] op_sel_hi:[1,0]
    v_pk_fma_f32 v[8:9], v[30:31], v[30:31], v[8:9]
    v_pk_add_f32 v[6:7], v[6:7], v[8:9]
    v_add_f32 v6, v6, v7
    s_nop 1
    v_add_f32_dpp v6, v6, v6 row_shr:1 row_mask:0xf bank_mask:0xf bound_ctrl:0
    s_nop 1
    v_add_f32_dpp v6, v6, v6 row_shr:2 row_mask:0xf bank_mask:0xf bound_ctrl:0
    s_nop 1
    v_add_f32_dpp v6, v6, v6 row_shr:4 row_mask:0xf bank_mask:0xf bound_ctrl:0
    s_nop 1
    v_add_f32_dpp v6, v6, v6 row_shr:8 row_mask:0xf bank_mask:0xf bound_ctrl:0
    s_nop 1
    v_add_f32_dpp v6, v6, v6 row_bcast:15 row_mask:0xa bank_mask:0xf
    s_nop 1
    v_add_f32_dpp v6, v6, v6 row_bcast:31 row_mask:0xc bank_mask:0xf
    s_mov_b64 exec, s[28:29]
    ds_write_b32 v2, v6 offset:832
    s_mov_b64 exec, -1
    s_waitcnt lgkmcnt(0)
    s_barrier
    ds_read_b128 v[16:19], v3 offset:832
    ds_read_b128 v[20:23], v3 offset:848
    ds_read_b128 v[24:27], v3 offset:864
    ds_read_b128 v[28:31], v3 offset:880
    s_waitcnt lgkmcnt(0)
    v_pk_add_f32 v[16:17], v[16:17], v[24:25]
    v_pk_add_f32 v[18:19], v[18:19], v[26:27]
    v_pk_add_f32 v[20:21], v[20:21], v[28:29]
    v_pk_add_f32 v[22:23], v[22:23], v[30:31]
    v_pk_add_f32 v[16:17], v[16:17], v[20:21]
    v_pk_add_f32 v[18:19], v[18:19], v[22:23]
    v_pk_add_f32 v[16:17], v[16:17], v[18:19]
    v_add_f32 v16, v16, v17
    s_cmp_lg_u32 s63, 255
    s_cbranch_scc1 L_noreset
    s_mov_b32 s24, 256
    s_mov_b32 s25, 224
    s_atomic_sub s24, s[12:13], 0
    s_atomic_sub s25, s[12:13], 64
    s_atomic_sub s24, s[12:13], 128
    s_waitcnt lgkmcnt(0)
L_noreset:
    s_and_b32 s30, s59, 1
    s_lshl_b32 s31, s47, 16
    s_and_b32 s24, s47, s27
    s_cmp_eq_u32 s30, 1
    s_cselect_b32 s24, s24, s31
    s_lshl_b32 s31, s53, 16
    s_and_b32 s25, s53, s27
    s_cmp_eq_u32 s30, 1
    s_cselect_b32 s25, s25, s31
    v_mul_f32 v17, 0x37800000, v16
    v_cvt_pk_bf16_f32 v17, v17, v17
    v_and_b32 v17, 0xffff0000, v17
    v_add_f32 v17, 0x3727c5ac, v17
    v_cvt_pk_bf16_f32 v17, v17, v17
    v_and_b32 v17, 0xffff0000, v17
    v_sqrt_f32 v17, v17
    s_nop 0
    v_cvt_pk_bf16_f32 v17, v17, v17
    v_and_b32 v17, 0xffff0000, v17
    v_rcp_f32 v12, v17
    s_nop 0
    v_fma_f32 v18, -v17, v12, 1.0
    v_fma_f32 v12, v18, v12, v12
    v_mul_f32 v12, s24, v12
    v_mov_b32 v14, s25
    v_fma_f32 v14, v10, v12, v14
    v_lshlrev_b32 v16, 16, v32
    v_and_b32 v17, 0xffff0000, v32
    v_pk_fma_f32 v[16:17], v[16:17], v[12:13], v[14:15] op_sel_hi:[1,0,0]
    v_cvt_pk_bf16_f32 v32, v16, v17
    v_lshlrev_b32 v18, 16, v33
    v_and_b32 v19, 0xffff0000, v33
    v_pk_fma_f32 v[18:19], v[18:19], v[12:13], v[14:15] op_sel_hi:[1,0,0]
    v_cvt_pk_bf16_f32 v33, v18, v19
    v_lshlrev_b32 v20, 16, v34
    v_and_b32 v21, 0xffff0000, v34
    v_pk_fma_f32 v[20:21], v[20:21], v[12:13], v[14:15] op_sel_hi:[1,0,0]
    v_cvt_pk_bf16_f32 v34, v20, v21
    v_lshlrev_b32 v22, 16, v35
    v_and_b32 v23, 0xffff0000, v35
    v_pk_fma_f32 v[22:23], v[22:23], v[12:13], v[14:15] op_sel_hi:[1,0,0]
    v_cvt_pk_bf16_f32 v35, v22, v23
    v_lshlrev_b32 v24, 16, v36
    v_and_b32 v25, 0xffff0000, v36
    v_pk_fma_f32 v[24:25], v[24:25], v[12:13], v[14:15] op_sel_hi:[1,0,0]
    v_cvt_pk_bf16_f32 v36, v24, v25
    v_lshlrev_b32 v26, 16, v37
    v_and_b32 v27, 0xffff0000, v37
    v_pk_fma_f32 v[26:27], v[26:27], v[12:13], v[14:15] op_sel_hi:[1,0,0]
    v_cvt_pk_bf16_f32 v37, v26, v27
    v_lshlrev_b32 v28, 16, v38
    v_and_b32 v29, 0xffff0000, v38
    v_pk_fma_f32 v[28:29], v[28:29], v[12:13], v[14:15] op_sel_hi:[1,0,0]
    v_cvt_pk_bf16_f32 v38, v28, v29
    v_lshlrev_b32 v30, 16, v39
    v_and_b32 v31, 0xffff0000, v39
    v_pk_fma_f32 v[30:31], v[30:31], v[12:13], v[14:15] op_sel_hi:[1,0,0]
    v_cvt_pk_bf16_f32 v39, v30, v31
    v_lshlrev_b32 v16, 16, v40
    v_and_b32 v17, 0xffff0000, v40
    v_pk_fma_f32 v[16:17], v[16:17], v[12:13], v[14:15] op_sel_hi:[1,0,0]
    v_cvt_pk_bf16_f32 v40, v16, v17
    v_lshlrev_b32 v18, 16, v41
    v_and_b32 v19, 0xffff0000, v41
    v_pk_fma_f32 v[18:19], v[18:19], v[12:13], v[14:15] op_sel_hi:[1,0,0]
    v_cvt_pk_bf16_f32 v41, v18, v19
    v_lshlrev_b32 v20, 16, v42
    v_and_b32 v21, 0xffff0000, v42
    v_pk_fma_f32 v[20:21], v[20:21], v[12:13], v[14:15] op_sel_hi:[1,0,0]
    v_cvt_pk_bf16_f32 v42, v20, v21
    v_lshlrev_b32 v22, 16, v43
    v_and_b32 v23, 0xffff0000, v43
    v_pk_fma_f32 v[22:23], v[22:23], v[12:13], v[14:15] op_sel_hi:[1,0,0]
    v_cvt_pk_bf16_f32 v43, v22, v23
    v_lshlrev_b32 v24, 16, v44
    v_and_b32 v25, 0xffff0000, v44
    v_pk_fma_f32 v[24:25], v[24:25], v[12:13], v[14:15] op_sel_hi:[1,0,0]
    v_cvt_pk_bf16_f32 v44, v24, v25
    v_lshlrev_b32 v26, 16, v45
    v_and_b32 v27, 0xffff0000, v45
    v_pk_fma_f32 v[26:27], v[26:27], v[12:13], v[14:15] op_sel_hi:[1,0,0]
    v_cvt_pk_bf16_f32 v45, v26, v27
    v_lshlrev_b32 v28, 16, v46
    v_and_b32 v29, 0xffff0000, v46
    v_pk_fma_f32 v[28:29], v[28:29], v[12:13], v[14:15] op_sel_hi:[1,0,0]
    v_cvt_pk_bf16_f32 v46, v28, v29
    v_lshlrev_b32 v30, 16, v47
    v_and_b32 v31, 0xffff0000, v47
    v_pk_fma_f32 v[30:31], v[30:31], v[12:13], v[14:15] op_sel_hi:[1,0,0]
    v_cvt_pk_bf16_f32 v47, v30, v31
    v_lshlrev_b32 v16, 16, v48
    v_and_b32 v17, 0xffff0000, v48
    v_pk_fma_f32 v[16:17], v[16:17], v[12:13], v[14:15] op_sel_hi:[1,0,0]
    v_cvt_pk_bf16_f32 v48, v16, v17
    v_lshlrev_b32 v18, 16, v49
    v_and_b32 v19, 0xffff0000, v49
    v_pk_fma_f32 v[18:19], v[18:19], v[12:13], v[14:15] op_sel_hi:[1,0,0]
    v_cvt_pk_bf16_f32 v49, v18, v19
    v_lshlrev_b32 v20, 16, v50
    v_and_b32 v21, 0xffff0000, v50
    v_pk_fma_f32 v[20:21], v[20:21], v[12:13], v[14:15] op_sel_hi:[1,0,0]
    v_cvt_pk_bf16_f32 v50, v20, v21
    v_lshlrev_b32 v22, 16, v51
    v_and_b32 v23, 0xffff0000, v51
    v_pk_fma_f32 v[22:23], v[22:23], v[12:13], v[14:15] op_sel_hi:[1,0,0]
    v_cvt_pk_bf16_f32 v51, v22, v23
    v_lshlrev_b32 v24, 16, v52
    v_and_b32 v25, 0xffff0000, v52
    v_pk_fma_f32 v[24:25], v[24:25], v[12:13], v[14:15] op_sel_hi:[1,0,0]
    v_cvt_pk_bf16_f32 v52, v24, v25
    v_lshlrev_b32 v26, 16, v53
    v_and_b32 v27, 0xffff0000, v53
    v_pk_fma_f32 v[26:27], v[26:27], v[12:13], v[14:15] op_sel_hi:[1,0,0]
    v_cvt_pk_bf16_f32 v53, v26, v27
    v_lshlrev_b32 v28, 16, v54
    v_and_b32 v29, 0xffff0000, v54
    v_pk_fma_f32 v[28:29], v[28:29], v[12:13], v[14:15] op_sel_hi:[1,0,0]
    v_cvt_pk_bf16_f32 v54, v28, v29
    v_lshlrev_b32 v30, 16, v55
    v_and_b32 v31, 0xffff0000, v55
    v_pk_fma_f32 v[30:31], v[30:31], v[12:13], v[14:15] op_sel_hi:[1,0,0]
    v_cvt_pk_bf16_f32 v55, v30, v31
    v_lshlrev_b32 v16, 16, v56
    v_and_b32 v17, 0xffff0000, v56
    v_pk_fma_f32 v[16:17], v[16:17], v[12:13], v[14:15] op_sel_hi:[1,0,0]
    v_cvt_pk_bf16_f32 v56, v16, v17
    v_lshlrev_b32 v18, 16, v57
    v_and_b32 v19, 0xffff0000, v57
    v_pk_fma_f32 v[18:19], v[18:19], v[12:13], v[14:15] op_sel_hi:[1,0,0]
    v_cvt_pk_bf16_f32 v57, v18, v19
    v_lshlrev_b32 v20, 16, v58
    v_and_b32 v21, 0xffff0000, v58
    v_pk_fma_f32 v[20:21], v[20:21], v[12:13], v[14:15] op_sel_hi:[1,0,0]
    v_cvt_pk_bf16_f32 v58, v20, v21
    v_lshlrev_b32 v22, 16, v59
    v_and_b32 v23, 0xffff0000, v59
    v_pk_fma_f32 v[22:23], v[22:23], v[12:13], v[14:15] op_sel_hi:[1,0,0]
    v_cvt_pk_bf16_f32 v59, v22, v23
    v_lshlrev_b32 v24, 16, v60
    v_and_b32 v25, 0xffff0000, v60
    v_pk_fma_f32 v[24:25], v[24:25], v[12:13], v[14:15] op_sel_hi:[1,0,0]
    v_cvt_pk_bf16_f32 v60, v24, v25
    v_lshlrev_b32 v26, 16, v61
    v_and_b32 v27, 0xffff0000, v61
    v_pk_fma_f32 v[26:27], v[26:27], v[12:13], v[14:15] op_sel_hi:[1,0,0]
    v_cvt_pk_bf16_f32 v61, v26, v27
    v_lshlrev_b32 v28, 16, v62
    v_and_b32 v29, 0xffff0000, v62
    v_pk_fma_f32 v[28:29], v[28:29], v[12:13], v[14:15] op_sel_hi:[1,0,0]
    v_cvt_pk_bf16_f32 v62, v28, v29
    v_lshlrev_b32 v30, 16, v63
    v_and_b32 v31, 0xffff0000, v63
    v_pk_fma_f32 v[30:31], v[30:31], v[12:13], v[14:15] op_sel_hi:[1,0,0]
    v_cvt_pk_bf16_f32 v63, v30, v31
    buffer_store_dwordx4 v[32:35], v1, s[20:23], s38 offen offset:0
    buffer_store_dwordx4 v[36:39], v1, s[20:23], s38 offen offset:1024
    buffer_store_dwordx4 v[40:43], v1, s[20:23], s38 offen offset:2048
    buffer_store_dwordx4 v[44:47], v1, s[20:23], s38 offen offset:3072
    buffer_store_dwordx4 v[48:51], v1, s[20:23], s39 offen offset:0
    buffer_store_dwordx4 v[52:55], v1, s[20:23], s39 offen offset:1024
    buffer_store_dwordx4 v[56:59], v1, s[20:23], s39 offen offset:2048
    buffer_store_dwordx4 v[60:63], v1, s[20:23], s39 offen offset:3072
    s_cmp_eq_u32 s64, 0
    s_cbranch_scc1 L_fin
    v_mov_b32 v6, 0
    v_mov_b32 v7, 0
    v_mov_b32 v8, 0
    v_mov_b32 v9, 0
    s_waitcnt vmcnt(31)
    v_dot2c_f32_bf16 v6, v64, v4
    v_dot2c_f32_bf16 v7, v65, v4
    v_dot2c_f32_bf16 v8, v66, v4
    v_dot2c_f32_bf16 v9, v67, v4
    s_waitcnt vmcnt(30)
    v_dot2c_f32_bf16 v6, v68, v4
    v_dot2c_f32_bf16 v7, v69, v4
    v_dot2c_f32_bf16 v8, v70, v4
    v_dot2c_f32_bf16 v9, v71, v4
    s_waitcnt vmcnt(29)
    v_dot2c_f32_bf16 v6, v72, v4
    v_dot2c_f32_bf16 v7, v73, v4
    v_dot2c_f32_bf16 v8, v74, v4
    v_dot2c_f32_bf16 v9, v75, v4
    s_waitcnt vmcnt(28)
    v_dot2c_f32_bf16 v6, v76, v4
    v_dot2c_f32_bf16 v7, v77, v4
    v_dot2c_f32_bf16 v8, v78, v4
    v_dot2c_f32_bf16 v9, v79, v4
    s_waitcnt vmcnt(27)
    v_dot2c_f32_bf16 v6, v80, v4
    v_dot2c_f32_bf16 v7, v81, v4
    v_dot2c_f32_bf16 v8, v82, v4
    v_dot2c_f32_bf16 v9, v83, v4
    s_waitcnt vmcnt(26)
    v_dot2c_f32_bf16 v6, v84, v4
    v_dot2c_f32_bf16 v7, v85, v4
    v_dot2c_f32_bf16 v8, v86, v4
    v_dot2c_f32_bf16 v9, v87, v4
    s_waitcnt vmcnt(25)
    v_dot2c_f32_bf16 v6, v88, v4
    v_dot2c_f32_bf16 v7, v89, v4
    v_dot2c_f32_bf16 v8, v90, v4
    v_dot2c_f32_bf16 v9, v91, v4
    s_waitcnt vmcnt(24)
    v_dot2c_f32_bf16 v6, v92, v4
    v_dot2c_f32_bf16 v7, v93, v4
    v_dot2c_f32_bf16 v8, v94, v4
    v_dot2c_f32_bf16 v9, v95, v4
    s_nop 2
    v_add_f32 v6, v6, v7
    v_add_f32 v8, v8, v9
    v_add_f32 v6, v6, v8
    s_nop 1
    v_add_f32_dpp v6, v6, v6 row_shr:1 row_mask:0xf bank_mask:0xf bound_ctrl:0
    s_nop 1
    v_add_f32_dpp v6, v6, v6 row_shr:2 row_mask:0xf bank_mask:0xf bound_ctrl:0
    s_nop 1
    v_add_f32_dpp v6, v6, v6 row_shr:4 row_mask:0xf bank_mask:0xf bound_ctrl:0
    s_nop 1
    v_add_f32_dpp v6, v6, v6 row_shr:8 row_mask:0xf bank_mask:0xf bound_ctrl:0
    s_nop 1
    v_add_f32_dpp v6, v6, v6 row_bcast:15 row_mask:0xa bank_mask:0xf
    s_nop 1
    v_add_f32_dpp v6, v6, v6 row_bcast:31 row_mask:0xc bank_mask:0xf
    s_mov_b64 exec, s[28:29]
    ds_write_b32 v2, v6 offset:1024
    s_mov_b64 exec, -1
    s_waitcnt lgkmcnt(0)
    s_barrier
    ds_read_b128 v[16:19], v3 offset:1024
    ds_read_b128 v[20:23], v3 offset:1040
    ds_read_b128 v[24:27], v3 offset:1056
    ds_read_b128 v[28:31], v3 offset:1072
    s_waitcnt lgkmcnt(0)
    v_pk_add_f32 v[16:17], v[16:17], v[24:25]
    v_pk_add_f32 v[18:19], v[18:19], v[26:27]
    v_pk_add_f32 v[20:21], v[20:21], v[28:29]
    v_pk_add_f32 v[22:23], v[22:23], v[30:31]
    v_pk_add_f32 v[16:17], v[16:17], v[20:21]
    v_pk_add_f32 v[18:19], v[18:19], v[22:23]
    v_pk_add_f32 v[16:17], v[16:17], v[18:19]
    v_add_f32 v16, v16, v17
    v_mul_f32 v10, 0x37800000, v16
    v_cvt_pk_bf16_f32 v10, v10, v10
    v_and_b32 v10, 0xffff0000, v10
    v_xor_b32 v10, 0x80000000, v10
    v_mov_b32 v6, 0
    v_mov_b32 v7, 0
    v_mov_b32 v8, 0
    v_mov_b32 v9, 0
    v_lshlrev_b32 v16, 16, v64
    v_and_b32 v17, 0xffff0000, v64
    v_pk_add_f32 v[16:17], v[16:17], v[10:11] op_sel_hi:[1,0]
    v_pk_fma_f32 v[6:7], v[16:17], v[16:17], v[6:7]
    v_lshlrev_b32 v18, 16, v65
    v_and_b32 v19, 0xffff0000, v65
    v_pk_add_f32 v[18:19], v[18:19], v[10:11] op_sel_hi:[1,0]
    v_pk_fma_f32 v[8:9], v[18:19], v[18:19], v[8:9]
    v_lshlrev_b32 v20, 16, v66
    v_and_b32 v21, 0xffff0000, v66
    v_pk_add_f32 v[20:21], v[20:21], v[10:11] op_sel_hi:[1,0]
    v_pk_fma_f32 v[6:7], v[20:21], v[20:21], v[6:7]
    v_lshlrev_b32 v22, 16, v67
    v_and_b32 v23, 0xffff0000, v67
    v_pk_add_f32 v[22:23], v[22:23], v[10:11] op_sel_hi:[1,0]
    v_pk_fma_f32 v[8:9], v[22:23], v[22:23], v[8:9]
    v_lshlrev_b32 v24, 16, v68
    v_and_b32 v25, 0xffff0000, v68
    v_pk_add_f32 v[24:25], v[24:25], v[10:11] op_sel_hi:[1,0]
    v_pk_fma_f32 v[6:7], v[24:25], v[24:25], v[6:7]
    v_lshlrev_b32 v26, 16, v69
    v_and_b32 v27, 0xffff0000, v69
    v_pk_add_f32 v[26:27], v[26:27], v[10:11] op_sel_hi:[1,0]
    v_pk_fma_f32 v[8:9], v[26:27], v[26:27], v[8:9]
    v_lshlrev_b32 v28, 16, v70
    v_and_b32 v29, 0xffff0000, v70
    v_pk_add_f32 v[28:29], v[28:29], v[10:11] op_sel_hi:[1,0]
    v_pk_fma_f32 v[6:7], v[28:29], v[28:29], v[6:7]
    v_lshlrev_b32 v30, 16, v71
    v_and_b32 v31, 0xffff0000, v71
    v_pk_add_f32 v[30:31], v[30:31], v[10:11] op_sel_hi:[1,0]
    v_pk_fma_f32 v[8:9], v[30:31], v[30:31], v[8:9]
    v_lshlrev_b32 v16, 16, v72
    v_and_b32 v17, 0xffff0000, v72
    v_pk_add_f32 v[16:17], v[16:17], v[10:11] op_sel_hi:[1,0]
    v_pk_fma_f32 v[6:7], v[16:17], v[16:17], v[6:7]
    v_lshlrev_b32 v18, 16, v73
    v_and_b32 v19, 0xffff0000, v73
    v_pk_add_f32 v[18:19], v[18:19], v[10:11] op_sel_hi:[1,0]
    v_pk_fma_f32 v[8:9], v[18:19], v[18:19], v[8:9]
    v_lshlrev_b32 v20, 16, v74
    v_and_b32 v21, 0xffff0000, v74
    v_pk_add_f32 v[20:21], v[20:21], v[10:11] op_sel_hi:[1,0]
    v_pk_fma_f32 v[6:7], v[20:21], v[20:21], v[6:7]
    v_lshlrev_b32 v22, 16, v75
    v_and_b32 v23, 0xffff0000, v75
    v_pk_add_f32 v[22:23], v[22:23], v[10:11] op_sel_hi:[1,0]
    v_pk_fma_f32 v[8:9], v[22:23], v[22:23], v[8:9]
    v_lshlrev_b32 v24, 16, v76
    v_and_b32 v25, 0xffff0000, v76
    v_pk_add_f32 v[24:25], v[24:25], v[10:11] op_sel_hi:[1,0]
    v_pk_fma_f32 v[6:7], v[24:25], v[24:25], v[6:7]
    v_lshlrev_b32 v26, 16, v77
    v_and_b32 v27, 0xffff0000, v77
    v_pk_add_f32 v[26:27], v[26:27], v[10:11] op_sel_hi:[1,0]
    v_pk_fma_f32 v[8:9], v[26:27], v[26:27], v[8:9]
    v_lshlrev_b32 v28, 16, v78
    v_and_b32 v29, 0xffff0000, v78
    v_pk_add_f32 v[28:29], v[28:29], v[10:11] op_sel_hi:[1,0]
    v_pk_fma_f32 v[6:7], v[28:29], v[28:29], v[6:7]
    v_lshlrev_b32 v30, 16, v79
    v_and_b32 v31, 0xffff0000, v79
    v_pk_add_f32 v[30:31], v[30:31], v[10:11] op_sel_hi:[1,0]
    v_pk_fma_f32 v[8:9], v[30:31], v[30:31], v[8:9]
    v_lshlrev_b32 v16, 16, v80
    v_and_b32 v17, 0xffff0000, v80
    v_pk_add_f32 v[16:17], v[16:17], v[10:11] op_sel_hi:[1,0]
    v_pk_fma_f32 v[6:7], v[16:17], v[16:17], v[6:7]
    v_lshlrev_b32 v18, 16, v81
    v_and_b32 v19, 0xffff0000, v81
    v_pk_add_f32 v[18:19], v[18:19], v[10:11] op_sel_hi:[1,0]
    v_pk_fma_f32 v[8:9], v[18:19], v[18:19], v[8:9]
    v_lshlrev_b32 v20, 16, v82
    v_and_b32 v21, 0xffff0000, v82
    v_pk_add_f32 v[20:21], v[20:21], v[10:11] op_sel_hi:[1,0]
    v_pk_fma_f32 v[6:7], v[20:21], v[20:21], v[6:7]
    v_lshlrev_b32 v22, 16, v83
    v_and_b32 v23, 0xffff0000, v83
    v_pk_add_f32 v[22:23], v[22:23], v[10:11] op_sel_hi:[1,0]
    v_pk_fma_f32 v[8:9], v[22:23], v[22:23], v[8:9]
    v_lshlrev_b32 v24, 16, v84
    v_and_b32 v25, 0xffff0000, v84
    v_pk_add_f32 v[24:25], v[24:25], v[10:11] op_sel_hi:[1,0]
    v_pk_fma_f32 v[6:7], v[24:25], v[24:25], v[6:7]
    v_lshlrev_b32 v26, 16, v85
    v_and_b32 v27, 0xffff0000, v85
    v_pk_add_f32 v[26:27], v[26:27], v[10:11] op_sel_hi:[1,0]
    v_pk_fma_f32 v[8:9], v[26:27], v[26:27], v[8:9]
    v_lshlrev_b32 v28, 16, v86
    v_and_b32 v29, 0xffff0000, v86
    v_pk_add_f32 v[28:29], v[28:29], v[10:11] op_sel_hi:[1,0]
    v_pk_fma_f32 v[6:7], v[28:29], v[28:29], v[6:7]
    v_lshlrev_b32 v30, 16, v87
    v_and_b32 v31, 0xffff0000, v87
    v_pk_add_f32 v[30:31], v[30:31], v[10:11] op_sel_hi:[1,0]
    v_pk_fma_f32 v[8:9], v[30:31], v[30:31], v[8:9]
    v_lshlrev_b32 v16, 16, v88
    v_and_b32 v17, 0xffff0000, v88
    v_pk_add_f32 v[16:17], v[16:17], v[10:11] op_sel_hi:[1,0]
    v_pk_fma_f32 v[6:7], v[16:17], v[16:17], v[6:7]
    v_lshlrev_b32 v18, 16, v89
    v_and_b32 v19, 0xffff0000, v89
    v_pk_add_f32 v[18:19], v[18:19], v[10:11] op_sel_hi:[1,0]
    v_pk_fma_f32 v[8:9], v[18:19], v[18:19], v[8:9]
    v_lshlrev_b32 v20, 16, v90
    v_and_b32 v21, 0xffff0000, v90
    v_pk_add_f32 v[20:21], v[20:21], v[10:11] op_sel_hi:[1,0]
    v_pk_fma_f32 v[6:7], v[20:21], v[20:21], v[6:7]
    v_lshlrev_b32 v22, 16, v91
    v_and_b32 v23, 0xffff0000, v91
    v_pk_add_f32 v[22:23], v[22:23], v[10:11] op_sel_hi:[1,0]
    v_pk_fma_f32 v[8:9], v[22:23], v[22:23], v[8:9]
    v_lshlrev_b32 v24, 16, v92
    v_and_b32 v25, 0xffff0000, v92
    v_pk_add_f32 v[24:25], v[24:25], v[10:11] op_sel_hi:[1,0]
    v_pk_fma_f32 v[6:7], v[24:25], v[24:25], v[6:7]
    v_lshlrev_b32 v26, 16, v93
    v_and_b32 v27, 0xffff0000, v93
    v_pk_add_f32 v[26:27], v[26:27], v[10:11] op_sel_hi:[1,0]
    v_pk_fma_f32 v[8:9], v[26:27], v[26:27], v[8:9]
    v_lshlrev_b32 v28, 16, v94
    v_and_b32 v29, 0xffff0000, v94
    v_pk_add_f32 v[28:29], v[28:29], v[10:11] op_sel_hi:[1,0]
    v_pk_fma_f32 v[6:7], v[28:29], v[28:29], v[6:7]
    v_lshlrev_b32 v30, 16, v95
    v_and_b32 v31, 0xffff0000, v95
    v_pk_add_f32 v[30:31], v[30:31], v[10:11] op_sel_hi:[1,0]
    v_pk_fma_f32 v[8:9], v[30:31], v[30:31], v[8:9]
    v_pk_add_f32 v[6:7], v[6:7], v[8:9]
    v_add_f32 v6, v6, v7
    s_nop 1
    v_add_f32_dpp v6, v6, v6 row_shr:1 row_mask:0xf bank_mask:0xf bound_ctrl:0
    s_nop 1
    v_add_f32_dpp v6, v6, v6 row_shr:2 row_mask:0xf bank_mask:0xf bound_ctrl:0
    s_nop 1
    v_add_f32_dpp v6, v6, v6 row_shr:4 row_mask:0xf bank_mask:0xf bound_ctrl:0
    s_nop 1
    v_add_f32_dpp v6, v6, v6 row_shr:8 row_mask:0xf bank_mask:0xf bound_ctrl:0
    s_nop 1
    v_add_f32_dpp v6, v6, v6 row_bcast:15 row_mask:0xa bank_mask:0xf
    s_nop 1
    v_add_f32_dpp v6, v6, v6 row_bcast:31 row_mask:0xc bank_mask:0xf
    s_mov_b64 exec, s[28:29]
    ds_write_b32 v2, v6 offset:1088
    s_mov_b64 exec, -1
    s_waitcnt lgkmcnt(0)
    s_barrier
    ds_read_b128 v[16:19], v3 offset:1088
    ds_read_b128 v[20:23], v3 offset:1104
    ds_read_b128 v[24:27], v3 offset:1120
    ds_read_b128 v[28:31], v3 offset:1136
    s_waitcnt lgkmcnt(0)
    v_pk_add_f32 v[16:17], v[16:17], v[24:25]
    v_pk_add_f32 v[18:19], v[18:19], v[26:27]
    v_pk_add_f32 v[20:21], v[20:21], v[28:29]
    v_pk_add_f32 v[22:23], v[22:23], v[30:31]
    v_pk_add_f32 v[16:17], v[16:17], v[20:21]
    v_pk_add_f32 v[18:19], v[18:19], v[22:23]
    v_pk_add_f32 v[16:17], v[16:17], v[18:19]
    v_add_f32 v16, v16, v17
    s_and_b32 s30, s60, 1
    s_lshl_b32 s31, s48, 16
    s_and_b32 s24, s48, s27
    s_cmp_eq_u32 s30, 1
    s_cselect_b32 s24, s24, s31
    s_lshl_b32 s31, s54, 16
    s_and_b32 s25, s54, s27
    s_cmp_eq_u32 s30, 1
    s_cselect_b32 s25, s25, s31
    v_mul_f32 v17, 0x37800000, v16
    v_cvt_pk_bf16_f32 v17, v17, v17
    v_and_b32 v17, 0xffff0000, v17
    v_add_f32 v17, 0x3727c5ac, v17
    v_cvt_pk_bf16_f32 v17, v17, v17
    v_and_b32 v17, 0xffff0000, v17
    v_sqrt_f32 v17, v17
    s_nop 0
    v_cvt_pk_bf16_f32 v17, v17, v17
    v_and_b32 v17, 0xffff0000, v17
    v_rcp_f32 v12, v17
    s_nop 0
    v_fma_f32 v18, -v17, v12, 1.0
    v_fma_f32 v12, v18, v12, v12
    v_mul_f32 v12, s24, v12
    v_mov_b32 v14, s25
    v_fma_f32 v14, v10, v12, v14
    v_lshlrev_b32 v16, 16, v64
    v_and_b32 v17, 0xffff0000, v64
    v_pk_fma_f32 v[16:17], v[16:17], v[12:13], v[14:15] op_sel_hi:[1,0,0]
    v_cvt_pk_bf16_f32 v64, v16, v17
    v_lshlrev_b32 v18, 16, v65
    v_and_b32 v19, 0xffff0000, v65
    v_pk_fma_f32 v[18:19], v[18:19], v[12:13], v[14:15] op_sel_hi:[1,0,0]
    v_cvt_pk_bf16_f32 v65, v18, v19
    v_lshlrev_b32 v20, 16, v66
    v_and_b32 v21, 0xffff0000, v66
    v_pk_fma_f32 v[20:21], v[20:21], v[12:13], v[14:15] op_sel_hi:[1,0,0]
    v_cvt_pk_bf16_f32 v66, v20, v21
    v_lshlrev_b32 v22, 16, v67
    v_and_b32 v23, 0xffff0000, v67
    v_pk_fma_f32 v[22:23], v[22:23], v[12:13], v[14:15] op_sel_hi:[1,0,0]
    v_cvt_pk_bf16_f32 v67, v22, v23
    v_lshlrev_b32 v24, 16, v68
    v_and_b32 v25, 0xffff0000, v68
    v_pk_fma_f32 v[24:25], v[24:25], v[12:13], v[14:15] op_sel_hi:[1,0,0]
    v_cvt_pk_bf16_f32 v68, v24, v25
    v_lshlrev_b32 v26, 16, v69
    v_and_b32 v27, 0xffff0000, v69
    v_pk_fma_f32 v[26:27], v[26:27], v[12:13], v[14:15] op_sel_hi:[1,0,0]
    v_cvt_pk_bf16_f32 v69, v26, v27
    v_lshlrev_b32 v28, 16, v70
    v_and_b32 v29, 0xffff0000, v70
    v_pk_fma_f32 v[28:29], v[28:29], v[12:13], v[14:15] op_sel_hi:[1,0,0]
    v_cvt_pk_bf16_f32 v70, v28, v29
    v_lshlrev_b32 v30, 16, v71
    v_and_b32 v31, 0xffff0000, v71
    v_pk_fma_f32 v[30:31], v[30:31], v[12:13], v[14:15] op_sel_hi:[1,0,0]
    v_cvt_pk_bf16_f32 v71, v30, v31
    v_lshlrev_b32 v16, 16, v72
    v_and_b32 v17, 0xffff0000, v72
    v_pk_fma_f32 v[16:17], v[16:17], v[12:13], v[14:15] op_sel_hi:[1,0,0]
    v_cvt_pk_bf16_f32 v72, v16, v17
    v_lshlrev_b32 v18, 16, v73
    v_and_b32 v19, 0xffff0000, v73
    v_pk_fma_f32 v[18:19], v[18:19], v[12:13], v[14:15] op_sel_hi:[1,0,0]
    v_cvt_pk_bf16_f32 v73, v18, v19
    v_lshlrev_b32 v20, 16, v74
    v_and_b32 v21, 0xffff0000, v74
    v_pk_fma_f32 v[20:21], v[20:21], v[12:13], v[14:15] op_sel_hi:[1,0,0]
    v_cvt_pk_bf16_f32 v74, v20, v21
    v_lshlrev_b32 v22, 16, v75
    v_and_b32 v23, 0xffff0000, v75
    v_pk_fma_f32 v[22:23], v[22:23], v[12:13], v[14:15] op_sel_hi:[1,0,0]
    v_cvt_pk_bf16_f32 v75, v22, v23
    v_lshlrev_b32 v24, 16, v76
    v_and_b32 v25, 0xffff0000, v76
    v_pk_fma_f32 v[24:25], v[24:25], v[12:13], v[14:15] op_sel_hi:[1,0,0]
    v_cvt_pk_bf16_f32 v76, v24, v25
    v_lshlrev_b32 v26, 16, v77
    v_and_b32 v27, 0xffff0000, v77
    v_pk_fma_f32 v[26:27], v[26:27], v[12:13], v[14:15] op_sel_hi:[1,0,0]
    v_cvt_pk_bf16_f32 v77, v26, v27
    v_lshlrev_b32 v28, 16, v78
    v_and_b32 v29, 0xffff0000, v78
    v_pk_fma_f32 v[28:29], v[28:29], v[12:13], v[14:15] op_sel_hi:[1,0,0]
    v_cvt_pk_bf16_f32 v78, v28, v29
    v_lshlrev_b32 v30, 16, v79
    v_and_b32 v31, 0xffff0000, v79
    v_pk_fma_f32 v[30:31], v[30:31], v[12:13], v[14:15] op_sel_hi:[1,0,0]
    v_cvt_pk_bf16_f32 v79, v30, v31
    v_lshlrev_b32 v16, 16, v80
    v_and_b32 v17, 0xffff0000, v80
    v_pk_fma_f32 v[16:17], v[16:17], v[12:13], v[14:15] op_sel_hi:[1,0,0]
    v_cvt_pk_bf16_f32 v80, v16, v17
    v_lshlrev_b32 v18, 16, v81
    v_and_b32 v19, 0xffff0000, v81
    v_pk_fma_f32 v[18:19], v[18:19], v[12:13], v[14:15] op_sel_hi:[1,0,0]
    v_cvt_pk_bf16_f32 v81, v18, v19
    v_lshlrev_b32 v20, 16, v82
    v_and_b32 v21, 0xffff0000, v82
    v_pk_fma_f32 v[20:21], v[20:21], v[12:13], v[14:15] op_sel_hi:[1,0,0]
    v_cvt_pk_bf16_f32 v82, v20, v21
    v_lshlrev_b32 v22, 16, v83
    v_and_b32 v23, 0xffff0000, v83
    v_pk_fma_f32 v[22:23], v[22:23], v[12:13], v[14:15] op_sel_hi:[1,0,0]
    v_cvt_pk_bf16_f32 v83, v22, v23
    v_lshlrev_b32 v24, 16, v84
    v_and_b32 v25, 0xffff0000, v84
    v_pk_fma_f32 v[24:25], v[24:25], v[12:13], v[14:15] op_sel_hi:[1,0,0]
    v_cvt_pk_bf16_f32 v84, v24, v25
    v_lshlrev_b32 v26, 16, v85
    v_and_b32 v27, 0xffff0000, v85
    v_pk_fma_f32 v[26:27], v[26:27], v[12:13], v[14:15] op_sel_hi:[1,0,0]
    v_cvt_pk_bf16_f32 v85, v26, v27
    v_lshlrev_b32 v28, 16, v86
    v_and_b32 v29, 0xffff0000, v86
    v_pk_fma_f32 v[28:29], v[28:29], v[12:13], v[14:15] op_sel_hi:[1,0,0]
    v_cvt_pk_bf16_f32 v86, v28, v29
    v_lshlrev_b32 v30, 16, v87
    v_and_b32 v31, 0xffff0000, v87
    v_pk_fma_f32 v[30:31], v[30:31], v[12:13], v[14:15] op_sel_hi:[1,0,0]
    v_cvt_pk_bf16_f32 v87, v30, v31
    v_lshlrev_b32 v16, 16, v88
    v_and_b32 v17, 0xffff0000, v88
    v_pk_fma_f32 v[16:17], v[16:17], v[12:13], v[14:15] op_sel_hi:[1,0,0]
    v_cvt_pk_bf16_f32 v88, v16, v17
    v_lshlrev_b32 v18, 16, v89
    v_and_b32 v19, 0xffff0000, v89
    v_pk_fma_f32 v[18:19], v[18:19], v[12:13], v[14:15] op_sel_hi:[1,0,0]
    v_cvt_pk_bf16_f32 v89, v18, v19
    v_lshlrev_b32 v20, 16, v90
    v_and_b32 v21, 0xffff0000, v90
    v_pk_fma_f32 v[20:21], v[20:21], v[12:13], v[14:15] op_sel_hi:[1,0,0]
    v_cvt_pk_bf16_f32 v90, v20, v21
    v_lshlrev_b32 v22, 16, v91
    v_and_b32 v23, 0xffff0000, v91
    v_pk_fma_f32 v[22:23], v[22:23], v[12:13], v[14:15] op_sel_hi:[1,0,0]
    v_cvt_pk_bf16_f32 v91, v22, v23
    v_lshlrev_b32 v24, 16, v92
    v_and_b32 v25, 0xffff0000, v92
    v_pk_fma_f32 v[24:25], v[24:25], v[12:13], v[14:15] op_sel_hi:[1,0,0]
    v_cvt_pk_bf16_f32 v92, v24, v25
    v_lshlrev_b32 v26, 16, v93
    v_and_b32 v27, 0xffff0000, v93
    v_pk_fma_f32 v[26:27], v[26:27], v[12:13], v[14:15] op_sel_hi:[1,0,0]
    v_cvt_pk_bf16_f32 v93, v26, v27
    v_lshlrev_b32 v28, 16, v94
    v_and_b32 v29, 0xffff0000, v94
    v_pk_fma_f32 v[28:29], v[28:29], v[12:13], v[14:15] op_sel_hi:[1,0,0]
    v_cvt_pk_bf16_f32 v94, v28, v29
    v_lshlrev_b32 v30, 16, v95
    v_and_b32 v31, 0xffff0000, v95
    v_pk_fma_f32 v[30:31], v[30:31], v[12:13], v[14:15] op_sel_hi:[1,0,0]
    v_cvt_pk_bf16_f32 v95, v30, v31
    buffer_store_dwordx4 v[64:67], v1, s[20:23], s40 offen offset:0
    buffer_store_dwordx4 v[68:71], v1, s[20:23], s40 offen offset:1024
    buffer_store_dwordx4 v[72:75], v1, s[20:23], s40 offen offset:2048
    buffer_store_dwordx4 v[76:79], v1, s[20:23], s40 offen offset:3072
    buffer_store_dwordx4 v[80:83], v1, s[20:23], s41 offen offset:0
    buffer_store_dwordx4 v[84:87], v1, s[20:23], s41 offen offset:1024
    buffer_store_dwordx4 v[88:91], v1, s[20:23], s41 offen offset:2048
    buffer_store_dwordx4 v[92:95], v1, s[20:23], s41 offen offset:3072
    s_cmp_eq_u32 s65, 0
    s_cbranch_scc1 L_fin
    v_mov_b32 v6, 0
    v_mov_b32 v7, 0
    v_mov_b32 v8, 0
    v_mov_b32 v9, 0
    s_waitcnt vmcnt(23)
    v_dot2c_f32_bf16 v6, v96, v4
    v_dot2c_f32_bf16 v7, v97, v4
    v_dot2c_f32_bf16 v8, v98, v4
    v_dot2c_f32_bf16 v9, v99, v4
    s_waitcnt vmcnt(22)
    v_dot2c_f32_bf16 v6, v100, v4
    v_dot2c_f32_bf16 v7, v101, v4
    v_dot2c_f32_bf16 v8, v102, v4
    v_dot2c_f32_bf16 v9, v103, v4
    s_waitcnt vmcnt(21)
    v_dot2c_f32_bf16 v6, v104, v4
    v_dot2c_f32_bf16 v7, v105, v4
    v_dot2c_f32_bf16 v8, v106, v4
    v_dot2c_f32_bf16 v9, v107, v4
    s_waitcnt vmcnt(20)
    v_dot2c_f32_bf16 v6, v108, v4
    v_dot2c_f32_bf16 v7, v109, v4
    v_dot2c_f32_bf16 v8, v110, v4
    v_dot2c_f32_bf16 v9, v111, v4
    s_waitcnt vmcnt(19)
    v_dot2c_f32_bf16 v6, v112, v4
    v_dot2c_f32_bf16 v7, v113, v4
    v_dot2c_f32_bf16 v8, v114, v4
    v_dot2c_f32_bf16 v9, v115, v4
    s_waitcnt vmcnt(18)
    v_dot2c_f32_bf16 v6, v116, v4
    v_dot2c_f32_bf16 v7, v117, v4
    v_dot2c_f32_bf16 v8, v118, v4
    v_dot2c_f32_bf16 v9, v119, v4
    s_waitcnt vmcnt(17)
    v_dot2c_f32_bf16 v6, v120, v4
    v_dot2c_f32_bf16 v7, v121, v4
    v_dot2c_f32_bf16 v8, v122, v4
    v_dot2c_f32_bf16 v9, v123, v4
    s_waitcnt vmcnt(16)
    v_dot2c_f32_bf16 v6, v124, v4
    v_dot2c_f32_bf16 v7, v125, v4
    v_dot2c_f32_bf16 v8, v126, v4
    v_dot2c_f32_bf16 v9, v127, v4
    s_nop 2
    v_add_f32 v6, v6, v7
    v_add_f32 v8, v8, v9
    v_add_f32 v6, v6, v8
    s_nop 1
    v_add_f32_dpp v6, v6, v6 row_shr:1 row_mask:0xf bank_mask:0xf bound_ctrl:0
    s_nop 1
    v_add_f32_dpp v6, v6, v6 row_shr:2 row_mask:0xf bank_mask:0xf bound_ctrl:0
    s_nop 1
    v_add_f32_dpp v6, v6, v6 row_shr:4 row_mask:0xf bank_mask:0xf bound_ctrl:0
    s_nop 1
    v_add_f32_dpp v6, v6, v6 row_shr:8 row_mask:0xf bank_mask:0xf bound_ctrl:0
    s_nop 1
    v_add_f32_dpp v6, v6, v6 row_bcast:15 row_mask:0xa bank_mask:0xf
    s_nop 1
    v_add_f32_dpp v6, v6, v6 row_bcast:31 row_mask:0xc bank_mask:0xf
    s_mov_b64 exec, s[28:29]
    ds_write_b32 v2, v6 offset:1280
    s_mov_b64 exec, -1
    s_waitcnt lgkmcnt(0)
    s_barrier
    ds_read_b128 v[16:19], v3 offset:1280
    ds_read_b128 v[20:23], v3 offset:1296
    ds_read_b128 v[24:27], v3 offset:1312
    ds_read_b128 v[28:31], v3 offset:1328
    s_waitcnt lgkmcnt(0)
    v_pk_add_f32 v[16:17], v[16:17], v[24:25]
    v_pk_add_f32 v[18:19], v[18:19], v[26:27]
    v_pk_add_f32 v[20:21], v[20:21], v[28:29]
    v_pk_add_f32 v[22:23], v[22:23], v[30:31]
    v_pk_add_f32 v[16:17], v[16:17], v[20:21]
    v_pk_add_f32 v[18:19], v[18:19], v[22:23]
    v_pk_add_f32 v[16:17], v[16:17], v[18:19]
    v_add_f32 v16, v16, v17
    v_mul_f32 v10, 0x37800000, v16
    v_cvt_pk_bf16_f32 v10, v10, v10
    v_and_b32 v10, 0xffff0000, v10
    v_xor_b32 v10, 0x80000000, v10
    v_mov_b32 v6, 0
    v_mov_b32 v7, 0
    v_mov_b32 v8, 0
    v_mov_b32 v9, 0
    v_lshlrev_b32 v16, 16, v96
    v_and_b32 v17, 0xffff0000, v96
    v_pk_add_f32 v[16:17], v[16:17], v[10:11] op_sel_hi:[1,0]
    v_pk_fma_f32 v[6:7], v[16:17], v[16:17], v[6:7]
    v_lshlrev_b32 v18, 16, v97
    v_and_b32 v19, 0xffff0000, v97
    v_pk_add_f32 v[18:19], v[18:19], v[10:11] op_sel_hi:[1,0]
    v_pk_fma_f32 v[8:9], v[18:19], v[18:19], v[8:9]
    v_lshlrev_b32 v20, 16, v98
    v_and_b32 v21, 0xffff0000, v98
    v_pk_add_f32 v[20:21], v[20:21], v[10:11] op_sel_hi:[1,0]
    v_pk_fma_f32 v[6:7], v[20:21], v[20:21], v[6:7]
    v_lshlrev_b32 v22, 16, v99
    v_and_b32 v23, 0xffff0000, v99
    v_pk_add_f32 v[22:23], v[22:23], v[10:11] op_sel_hi:[1,0]
    v_pk_fma_f32 v[8:9], v[22:23], v[22:23], v[8:9]
    v_lshlrev_b32 v24, 16, v100
    v_and_b32 v25, 0xffff0000, v100
    v_pk_add_f32 v[24:25], v[24:25], v[10:11] op_sel_hi:[1,0]
    v_pk_fma_f32 v[6:7], v[24:25], v[24:25], v[6:7]
    v_lshlrev_b32 v26, 16, v101
    v_and_b32 v27, 0xffff0000, v101
    v_pk_add_f32 v[26:27], v[26:27], v[10:11] op_sel_hi:[1,0]
    v_pk_fma_f32 v[8:9], v[26:27], v[26:27], v[8:9]
    v_lshlrev_b32 v28, 16, v102
    v_and_b32 v29, 0xffff0000, v102
    v_pk_add_f32 v[28:29], v[28:29], v[10:11] op_sel_hi:[1,0]
    v_pk_fma_f32 v[6:7], v[28:29], v[28:29], v[6:7]
    v_lshlrev_b32 v30, 16, v103
    v_and_b32 v31, 0xffff0000, v103
    v_pk_add_f32 v[30:31], v[30:31], v[10:11] op_sel_hi:[1,0]
    v_pk_fma_f32 v[8:9], v[30:31], v[30:31], v[8:9]
    v_lshlrev_b32 v16, 16, v104
    v_and_b32 v17, 0xffff0000, v104
    v_pk_add_f32 v[16:17], v[16:17], v[10:11] op_sel_hi:[1,0]
    v_pk_fma_f32 v[6:7], v[16:17], v[16:17], v[6:7]
    v_lshlrev_b32 v18, 16, v105
    v_and_b32 v19, 0xffff0000, v105
    v_pk_add_f32 v[18:19], v[18:19], v[10:11] op_sel_hi:[1,0]
    v_pk_fma_f32 v[8:9], v[18:19], v[18:19], v[8:9]
    v_lshlrev_b32 v20, 16, v106
    v_and_b32 v21, 0xffff0000, v106
    v_pk_add_f32 v[20:21], v[20:21], v[10:11] op_sel_hi:[1,0]
    v_pk_fma_f32 v[6:7], v[20:21], v[20:21], v[6:7]
    v_lshlrev_b32 v22, 16, v107
    v_and_b32 v23, 0xffff0000, v107
    v_pk_add_f32 v[22:23], v[22:23], v[10:11] op_sel_hi:[1,0]
    v_pk_fma_f32 v[8:9], v[22:23], v[22:23], v[8:9]
    v_lshlrev_b32 v24, 16, v108
    v_and_b32 v25, 0xffff0000, v108
    v_pk_add_f32 v[24:25], v[24:25], v[10:11] op_sel_hi:[1,0]
    v_pk_fma_f32 v[6:7], v[24:25], v[24:25], v[6:7]
    v_lshlrev_b32 v26, 16, v109
    v_and_b32 v27, 0xffff0000, v109
    v_pk_add_f32 v[26:27], v[26:27], v[10:11] op_sel_hi:[1,0]
    v_pk_fma_f32 v[8:9], v[26:27], v[26:27], v[8:9]
    v_lshlrev_b32 v28, 16, v110
    v_and_b32 v29, 0xffff0000, v110
    v_pk_add_f32 v[28:29], v[28:29], v[10:11] op_sel_hi:[1,0]
    v_pk_fma_f32 v[6:7], v[28:29], v[28:29], v[6:7]
    v_lshlrev_b32 v30, 16, v111
    v_and_b32 v31, 0xffff0000, v111
    v_pk_add_f32 v[30:31], v[30:31], v[10:11] op_sel_hi:[1,0]
    v_pk_fma_f32 v[8:9], v[30:31], v[30:31], v[8:9]
    v_lshlrev_b32 v16, 16, v112
    v_and_b32 v17, 0xffff0000, v112
    v_pk_add_f32 v[16:17], v[16:17], v[10:11] op_sel_hi:[1,0]
    v_pk_fma_f32 v[6:7], v[16:17], v[16:17], v[6:7]
    v_lshlrev_b32 v18, 16, v113
    v_and_b32 v19, 0xffff0000, v113
    v_pk_add_f32 v[18:19], v[18:19], v[10:11] op_sel_hi:[1,0]
    v_pk_fma_f32 v[8:9], v[18:19], v[18:19], v[8:9]
    v_lshlrev_b32 v20, 16, v114
    v_and_b32 v21, 0xffff0000, v114
    v_pk_add_f32 v[20:21], v[20:21], v[10:11] op_sel_hi:[1,0]
    v_pk_fma_f32 v[6:7], v[20:21], v[20:21], v[6:7]
    v_lshlrev_b32 v22, 16, v115
    v_and_b32 v23, 0xffff0000, v115
    v_pk_add_f32 v[22:23], v[22:23], v[10:11] op_sel_hi:[1,0]
    v_pk_fma_f32 v[8:9], v[22:23], v[22:23], v[8:9]
    v_lshlrev_b32 v24, 16, v116
    v_and_b32 v25, 0xffff0000, v116
    v_pk_add_f32 v[24:25], v[24:25], v[10:11] op_sel_hi:[1,0]
    v_pk_fma_f32 v[6:7], v[24:25], v[24:25], v[6:7]
    v_lshlrev_b32 v26, 16, v117
    v_and_b32 v27, 0xffff0000, v117
    v_pk_add_f32 v[26:27], v[26:27], v[10:11] op_sel_hi:[1,0]
    v_pk_fma_f32 v[8:9], v[26:27], v[26:27], v[8:9]
    v_lshlrev_b32 v28, 16, v118
    v_and_b32 v29, 0xffff0000, v118
    v_pk_add_f32 v[28:29], v[28:29], v[10:11] op_sel_hi:[1,0]
    v_pk_fma_f32 v[6:7], v[28:29], v[28:29], v[6:7]
    v_lshlrev_b32 v30, 16, v119
    v_and_b32 v31, 0xffff0000, v119
    v_pk_add_f32 v[30:31], v[30:31], v[10:11] op_sel_hi:[1,0]
    v_pk_fma_f32 v[8:9], v[30:31], v[30:31], v[8:9]
    v_lshlrev_b32 v16, 16, v120
    v_and_b32 v17, 0xffff0000, v120
    v_pk_add_f32 v[16:17], v[16:17], v[10:11] op_sel_hi:[1,0]
    v_pk_fma_f32 v[6:7], v[16:17], v[16:17], v[6:7]
    v_lshlrev_b32 v18, 16, v121
    v_and_b32 v19, 0xffff0000, v121
    v_pk_add_f32 v[18:19], v[18:19], v[10:11] op_sel_hi:[1,0]
    v_pk_fma_f32 v[8:9], v[18:19], v[18:19], v[8:9]
    v_lshlrev_b32 v20, 16, v122
    v_and_b32 v21, 0xffff0000, v122
    v_pk_add_f32 v[20:21], v[20:21], v[10:11] op_sel_hi:[1,0]
    v_pk_fma_f32 v[6:7], v[20:21], v[20:21], v[6:7]
    v_lshlrev_b32 v22, 16, v123
    v_and_b32 v23, 0xffff0000, v123
    v_pk_add_f32 v[22:23], v[22:23], v[10:11] op_sel_hi:[1,0]
    v_pk_fma_f32 v[8:9], v[22:23], v[22:23], v[8:9]
    v_lshlrev_b32 v24, 16, v124
    v_and_b32 v25, 0xffff0000, v124
    v_pk_add_f32 v[24:25], v[24:25], v[10:11] op_sel_hi:[1,0]
    v_pk_fma_f32 v[6:7], v[24:25], v[24:25], v[6:7]
    v_lshlrev_b32 v26, 16, v125
    v_and_b32 v27, 0xffff0000, v125
    v_pk_add_f32 v[26:27], v[26:27], v[10:11] op_sel_hi:[1,0]
    v_pk_fma_f32 v[8:9], v[26:27], v[26:27], v[8:9]
    v_lshlrev_b32 v28, 16, v126
    v_and_b32 v29, 0xffff0000, v126
    v_pk_add_f32 v[28:29], v[28:29], v[10:11] op_sel_hi:[1,0]
    v_pk_fma_f32 v[6:7], v[28:29], v[28:29], v[6:7]
    v_lshlrev_b32 v30, 16, v127
    v_and_b32 v31, 0xffff0000, v127
    v_pk_add_f32 v[30:31], v[30:31], v[10:11] op_sel_hi:[1,0]
    v_pk_fma_f32 v[8:9], v[30:31], v[30:31], v[8:9]
    v_pk_add_f32 v[6:7], v[6:7], v[8:9]
    v_add_f32 v6, v6, v7
    s_nop 1
    v_add_f32_dpp v6, v6, v6 row_shr:1 row_mask:0xf bank_mask:0xf bound_ctrl:0
    s_nop 1
    v_add_f32_dpp v6, v6, v6 row_shr:2 row_mask:0xf bank_mask:0xf bound_ctrl:0
    s_nop 1
    v_add_f32_dpp v6, v6, v6 row_shr:4 row_mask:0xf bank_mask:0xf bound_ctrl:0
    s_nop 1
    v_add_f32_dpp v6, v6, v6 row_shr:8 row_mask:0xf bank_mask:0xf bound_ctrl:0
    s_nop 1
    v_add_f32_dpp v6, v6, v6 row_bcast:15 row_mask:0xa bank_mask:0xf
    s_nop 1
    v_add_f32_dpp v6, v6, v6 row_bcast:31 row_mask:0xc bank_mask:0xf
    s_mov_b64 exec, s[28:29]
    ds_write_b32 v2, v6 offset:1344
    s_mov_b64 exec, -1
    s_waitcnt lgkmcnt(0)
    s_barrier
    ds_read_b128 v[16:19], v3 offset:1344
    ds_read_b128 v[20:23], v3 offset:1360
    ds_read_b128 v[24:27], v3 offset:1376
    ds_read_b128 v[28:31], v3 offset:1392
    s_waitcnt lgkmcnt(0)
    v_pk_add_f32 v[16:17], v[16:17], v[24:25]
    v_pk_add_f32 v[18:19], v[18:19], v[26:27]
    v_pk_add_f32 v[20:21], v[20:21], v[28:29]
    v_pk_add_f32 v[22:23], v[22:23], v[30:31]
    v_pk_add_f32 v[16:17], v[16:17], v[20:21]
    v_pk_add_f32 v[18:19], v[18:19], v[22:23]
    v_pk_add_f32 v[16:17], v[16:17], v[18:19]
    v_add_f32 v16, v16, v17
    s_and_b32 s30, s61, 1
    s_lshl_b32 s31, s49, 16
    s_and_b32 s24, s49, s27
    s_cmp_eq_u32 s30, 1
    s_cselect_b32 s24, s24, s31
    s_lshl_b32 s31, s55, 16
    s_and_b32 s25, s55, s27
    s_cmp_eq_u32 s30, 1
    s_cselect_b32 s25, s25, s31
    v_mul_f32 v17, 0x37800000, v16
    v_cvt_pk_bf16_f32 v17, v17, v17
    v_and_b32 v17, 0xffff0000, v17
    v_add_f32 v17, 0x3727c5ac, v17
    v_cvt_pk_bf16_f32 v17, v17, v17
    v_and_b32 v17, 0xffff0000, v17
    v_sqrt_f32 v17, v17
    s_nop 0
    v_cvt_pk_bf16_f32 v17, v17, v17
    v_and_b32 v17, 0xffff0000, v17
    v_rcp_f32 v12, v17
    s_nop 0
    v_fma_f32 v18, -v17, v12, 1.0
    v_fma_f32 v12, v18, v12, v12
    v_mul_f32 v12, s24, v12
    v_mov_b32 v14, s25
    v_fma_f32 v14, v10, v12, v14
    v_lshlrev_b32 v16, 16, v96
    v_and_b32 v17, 0xffff0000, v96
    v_pk_fma_f32 v[16:17], v[16:17], v[12:13], v[14:15] op_sel_hi:[1,0,0]
    v_cvt_pk_bf16_f32 v96, v16, v17
    v_lshlrev_b32 v18, 16, v97
    v_and_b32 v19, 0xffff0000, v97
    v_pk_fma_f32 v[18:19], v[18:19], v[12:13], v[14:15] op_sel_hi:[1,0,0]
    v_cvt_pk_bf16_f32 v97, v18, v19
    v_lshlrev_b32 v20, 16, v98
    v_and_b32 v21, 0xffff0000, v98
    v_pk_fma_f32 v[20:21], v[20:21], v[12:13], v[14:15] op_sel_hi:[1,0,0]
    v_cvt_pk_bf16_f32 v98, v20, v21
    v_lshlrev_b32 v22, 16, v99
    v_and_b32 v23, 0xffff0000, v99
    v_pk_fma_f32 v[22:23], v[22:23], v[12:13], v[14:15] op_sel_hi:[1,0,0]
    v_cvt_pk_bf16_f32 v99, v22, v23
    v_lshlrev_b32 v24, 16, v100
    v_and_b32 v25, 0xffff0000, v100
    v_pk_fma_f32 v[24:25], v[24:25], v[12:13], v[14:15] op_sel_hi:[1,0,0]
    v_cvt_pk_bf16_f32 v100, v24, v25
    v_lshlrev_b32 v26, 16, v101
    v_and_b32 v27, 0xffff0000, v101
    v_pk_fma_f32 v[26:27], v[26:27], v[12:13], v[14:15] op_sel_hi:[1,0,0]
    v_cvt_pk_bf16_f32 v101, v26, v27
    v_lshlrev_b32 v28, 16, v102
    v_and_b32 v29, 0xffff0000, v102
    v_pk_fma_f32 v[28:29], v[28:29], v[12:13], v[14:15] op_sel_hi:[1,0,0]
    v_cvt_pk_bf16_f32 v102, v28, v29
    v_lshlrev_b32 v30, 16, v103
    v_and_b32 v31, 0xffff0000, v103
    v_pk_fma_f32 v[30:31], v[30:31], v[12:13], v[14:15] op_sel_hi:[1,0,0]
    v_cvt_pk_bf16_f32 v103, v30, v31
    v_lshlrev_b32 v16, 16, v104
    v_and_b32 v17, 0xffff0000, v104
    v_pk_fma_f32 v[16:17], v[16:17], v[12:13], v[14:15] op_sel_hi:[1,0,0]
    v_cvt_pk_bf16_f32 v104, v16, v17
    v_lshlrev_b32 v18, 16, v105
    v_and_b32 v19, 0xffff0000, v105
    v_pk_fma_f32 v[18:19], v[18:19], v[12:13], v[14:15] op_sel_hi:[1,0,0]
    v_cvt_pk_bf16_f32 v105, v18, v19
    v_lshlrev_b32 v20, 16, v106
    v_and_b32 v21, 0xffff0000, v106
    v_pk_fma_f32 v[20:21], v[20:21], v[12:13], v[14:15] op_sel_hi:[1,0,0]
    v_cvt_pk_bf16_f32 v106, v20, v21
    v_lshlrev_b32 v22, 16, v107
    v_and_b32 v23, 0xffff0000, v107
    v_pk_fma_f32 v[22:23], v[22:23], v[12:13], v[14:15] op_sel_hi:[1,0,0]
    v_cvt_pk_bf16_f32 v107, v22, v23
    v_lshlrev_b32 v24, 16, v108
    v_and_b32 v25, 0xffff0000, v108
    v_pk_fma_f32 v[24:25], v[24:25], v[12:13], v[14:15] op_sel_hi:[1,0,0]
    v_cvt_pk_bf16_f32 v108, v24, v25
    v_lshlrev_b32 v26, 16, v109
    v_and_b32 v27, 0xffff0000, v109
    v_pk_fma_f32 v[26:27], v[26:27], v[12:13], v[14:15] op_sel_hi:[1,0,0]
    v_cvt_pk_bf16_f32 v109, v26, v27
    v_lshlrev_b32 v28, 16, v110
    v_and_b32 v29, 0xffff0000, v110
    v_pk_fma_f32 v[28:29], v[28:29], v[12:13], v[14:15] op_sel_hi:[1,0,0]
    v_cvt_pk_bf16_f32 v110, v28, v29
    v_lshlrev_b32 v30, 16, v111
    v_and_b32 v31, 0xffff0000, v111
    v_pk_fma_f32 v[30:31], v[30:31], v[12:13], v[14:15] op_sel_hi:[1,0,0]
    v_cvt_pk_bf16_f32 v111, v30, v31
    v_lshlrev_b32 v16, 16, v112
    v_and_b32 v17, 0xffff0000, v112
    v_pk_fma_f32 v[16:17], v[16:17], v[12:13], v[14:15] op_sel_hi:[1,0,0]
    v_cvt_pk_bf16_f32 v112, v16, v17
    v_lshlrev_b32 v18, 16, v113
    v_and_b32 v19, 0xffff0000, v113
    v_pk_fma_f32 v[18:19], v[18:19], v[12:13], v[14:15] op_sel_hi:[1,0,0]
    v_cvt_pk_bf16_f32 v113, v18, v19
    v_lshlrev_b32 v20, 16, v114
    v_and_b32 v21, 0xffff0000, v114
    v_pk_fma_f32 v[20:21], v[20:21], v[12:13], v[14:15] op_sel_hi:[1,0,0]
    v_cvt_pk_bf16_f32 v114, v20, v21
    v_lshlrev_b32 v22, 16, v115
    v_and_b32 v23, 0xffff0000, v115
    v_pk_fma_f32 v[22:23], v[22:23], v[12:13], v[14:15] op_sel_hi:[1,0,0]
    v_cvt_pk_bf16_f32 v115, v22, v23
    v_lshlrev_b32 v24, 16, v116
    v_and_b32 v25, 0xffff0000, v116
    v_pk_fma_f32 v[24:25], v[24:25], v[12:13], v[14:15] op_sel_hi:[1,0,0]
    v_cvt_pk_bf16_f32 v116, v24, v25
    v_lshlrev_b32 v26, 16, v117
    v_and_b32 v27, 0xffff0000, v117
    v_pk_fma_f32 v[26:27], v[26:27], v[12:13], v[14:15] op_sel_hi:[1,0,0]
    v_cvt_pk_bf16_f32 v117, v26, v27
    v_lshlrev_b32 v28, 16, v118
    v_and_b32 v29, 0xffff0000, v118
    v_pk_fma_f32 v[28:29], v[28:29], v[12:13], v[14:15] op_sel_hi:[1,0,0]
    v_cvt_pk_bf16_f32 v118, v28, v29
    v_lshlrev_b32 v30, 16, v119
    v_and_b32 v31, 0xffff0000, v119
    v_pk_fma_f32 v[30:31], v[30:31], v[12:13], v[14:15] op_sel_hi:[1,0,0]
    v_cvt_pk_bf16_f32 v119, v30, v31
    v_lshlrev_b32 v16, 16, v120
    v_and_b32 v17, 0xffff0000, v120
    v_pk_fma_f32 v[16:17], v[16:17], v[12:13], v[14:15] op_sel_hi:[1,0,0]
    v_cvt_pk_bf16_f32 v120, v16, v17
    v_lshlrev_b32 v18, 16, v121
    v_and_b32 v19, 0xffff0000, v121
    v_pk_fma_f32 v[18:19], v[18:19], v[12:13], v[14:15] op_sel_hi:[1,0,0]
    v_cvt_pk_bf16_f32 v121, v18, v19
    v_lshlrev_b32 v20, 16, v122
    v_and_b32 v21, 0xffff0000, v122
    v_pk_fma_f32 v[20:21], v[20:21], v[12:13], v[14:15] op_sel_hi:[1,0,0]
    v_cvt_pk_bf16_f32 v122, v20, v21
    v_lshlrev_b32 v22, 16, v123
    v_and_b32 v23, 0xffff0000, v123
    v_pk_fma_f32 v[22:23], v[22:23], v[12:13], v[14:15] op_sel_hi:[1,0,0]
    v_cvt_pk_bf16_f32 v123, v22, v23
    v_lshlrev_b32 v24, 16, v124
    v_and_b32 v25, 0xffff0000, v124
    v_pk_fma_f32 v[24:25], v[24:25], v[12:13], v[14:15] op_sel_hi:[1,0,0]
    v_cvt_pk_bf16_f32 v124, v24, v25
    v_lshlrev_b32 v26, 16, v125
    v_and_b32 v27, 0xffff0000, v125
    v_pk_fma_f32 v[26:27], v[26:27], v[12:13], v[14:15] op_sel_hi:[1,0,0]
    v_cvt_pk_bf16_f32 v125, v26, v27
    v_lshlrev_b32 v28, 16, v126
    v_and_b32 v29, 0xffff0000, v126
    v_pk_fma_f32 v[28:29], v[28:29], v[12:13], v[14:15] op_sel_hi:[1,0,0]
    v_cvt_pk_bf16_f32 v126, v28, v29
    v_lshlrev_b32 v30, 16, v127
    v_and_b32 v31, 0xffff0000, v127
    v_pk_fma_f32 v[30:31], v[30:31], v[12:13], v[14:15] op_sel_hi:[1,0,0]
    v_cvt_pk_bf16_f32 v127, v30, v31
    buffer_store_dwordx4 v[96:99], v1, s[20:23], s42 offen offset:0
    buffer_store_dwordx4 v[100:103], v1, s[20:23], s42 offen offset:1024
    buffer_store_dwordx4 v[104:107], v1, s[20:23], s42 offen offset:2048
    buffer_store_dwordx4 v[108:111], v1, s[20:23], s42 offen offset:3072
    buffer_store_dwordx4 v[112:115], v1, s[20:23], s43 offen offset:0
    buffer_store_dwordx4 v[116:119], v1, s[20:23], s43 offen offset:1024
    buffer_store_dwordx4 v[120:123], v1, s[20:23], s43 offen offset:2048
    buffer_store_dwordx4 v[124:127], v1, s[20:23], s43 offen offset:3072
L_fin:
L_end:
    s_endpgm
.section .rodata,"a"
.p2align 6
.amdhsa_kernel standalone__instancenorm__prompt_kernel
  .amdhsa_next_free_vgpr 128
  .amdhsa_next_free_sgpr 96
  .amdhsa_accum_offset 128
  .amdhsa_group_segment_fixed_size 0
  .amdhsa_kernarg_size 48
  .amdhsa_user_sgpr_count 2
  .amdhsa_user_sgpr_kernarg_segment_ptr 1
  .amdhsa_system_sgpr_workgroup_id_x 1
  .amdhsa_float_denorm_mode_32 3
.end_amdhsa_kernel
```
